```python
import torch

def _softmax(x, axis=-1):
    return torch.softmax(x, dim=axis)

def _gelu(x):
    return torch.nn.functional.gelu(x, approximate='tanh')

def _silu(x):
    return torch.nn.functional.silu(x)

def _sigmoid(x):
    return torch.sigmoid(x)

def _layernorm(x, axis=-1, eps=1e-05):
    m = x.mean(dim=axis, keepdim=True)
    v = x.var(dim=axis, keepdim=True, unbiased=False)
    return (x - m) / torch.sqrt(v + eps)

def _scatter_add(tgt, idx, src, axis=0):
    return tgt.clone().index_add_(axis, idx, src)

def _segment_sum(src, seg, n):
    out = torch.zeros((n,) + src.shape[1:], dtype=src.dtype)
    return out.index_add_(0, seg, src)

def _pad(x, pw):
    flat = tuple((v for pair in reversed(pw) for v in pair))
    return torch.nn.functional.pad(x, flat)
kernel_name = 'gather_scatter__tensor_product_equiv_tfn__graph'

def setup_inputs():

    _w = lambda a: (lambda t: t.to(torch.bfloat16) if t.is_floating_point() else t)(torch.as_tensor(a))
    N, deg, C, L, DE = (10000, 64, 64, 1, 16)
    E = N * deg
    M = (L + 1) ** 2
    src = (lambda lo, hi, *s: torch.randint(lo, hi, s))(0, N, E).to(torch.int64)
    dst = (lambda lo, hi, *s: torch.randint(lo, hi, s))(0, N, E).to(torch.int64)
    r = (lambda *s: torch.randn(*s, dtype=torch.bfloat16) * 0.05)(E, 3)
    r = r / (torch.linalg.norm(r, dim=-1, keepdim=True) + 1e-09)
    rx, ry, rz = (r[:, 0].clone(), r[:, 1].clone(), r[:, 2].clone())
    Ys = [torch.ones((E, 1), dtype=float)]
    if L >= 1:
        Ys.append(r.to(float))
    if L >= 2:
        Ys.append(torch.stack([2 * rx * ry, 2 * ry * rz, (3 * rz * rz - 1.0) / (lambda _x: torch.sqrt(torch.as_tensor(_x)))(3.0), 2 * rx * rz, rx * rx - ry * ry], dim=-1).to(float))
    for _l in range(3, L + 1):
        Ys.append(((lambda *s: torch.randn(*s, dtype=torch.bfloat16) * 0.05)(E, 2 * _l + 1) * 0.3).to(float))
    Y = torch.cat(Ys, dim=-1)
    cg = torch.zeros((M, M, M), dtype=float)
    off = [_l * _l for _l in range(L + 2)]
    for l1 in range(L + 1):
        for l2 in range(L + 1):
            for l3 in range(abs(l1 - l2), min(L, l1 + l2) + 1):
                d1, d2, d3 = (2 * l1 + 1, 2 * l2 + 1, 2 * l3 + 1)
                cg[off[l1]:off[l1 + 1], off[l2]:off[l2 + 1], off[l3]:off[l3 + 1]] = (lambda *s: torch.randn(*s, dtype=torch.bfloat16) * 0.05)(d1, d2, d3) / (lambda _x: torch.sqrt(torch.as_tensor(_x)))(float(d1 * d2))
    return {'x': _w((lambda *s: torch.randn(*s, dtype=torch.bfloat16) * 0.05)(N, C, M) * 0.2), 'src': _w(src), 'dst': _w(dst), 'Y': _w(Y), 'edge_feat': _w((lambda *s: torch.randn(*s, dtype=torch.bfloat16) * 0.05)(E, DE)), 'w_rad': _w((lambda *s: torch.randn(*s, dtype=torch.bfloat16) * 0.05)(DE, C) * (1.0 / max(1.0, DE) ** 0.5)), 'cg': _w(cg), 'w_mix': _w((lambda *s: torch.randn(*s, dtype=torch.bfloat16) * 0.05)(C, C) * (1.0 / max(1.0, C) ** 0.5))}

def reference(x, src, dst, Y, edge_feat, w_rad, cg, w_mix):
    N, C, M = (x.shape[0], x.shape[1], x.shape[2])
    R = _silu(edge_feat @ w_rad)
    xs = x[src]
    tp = torch.einsum('eci,ef,ifo->eco', xs, Y, cg)
    msg = R[:, :, None] * tp
    agg = _segment_sum(msg.reshape(-1, C * M), dst, N).reshape(N, C, M)
    return torch.einsum('ncm,cd->ndm', agg, w_mix)
```

```asm
; @launch grid=(256,1,1) block=(1024,1,1) lds=163840
.amdgcn_target "amdgcn-amd-amdhsa--gfx950"
.text
.globl gather_scatter__tensor_product_equiv_tfn__graph_kernel
.p2align 8
.type gather_scatter__tensor_product_equiv_tfn__graph_kernel,@function
gather_scatter__tensor_product_equiv_tfn__graph_kernel:
    s_cmp_ge_u32 s2, 256
    s_cbranch_scc1 k2_end
    s_load_dwordx4 s[4:7], s[0:1], 8
    s_load_dwordx4 s[8:11], s[0:1], 24
    s_load_dwordx4 s[12:15], s[0:1], 40
    s_load_dwordx2 s[16:17], s[0:1], 56
    s_load_dwordx2 s[18:19], s[0:1], 80
    s_load_dwordx2 s[68:69], s[0:1], 0
    s_load_dwordx2 s[70:71], s[0:1], 64
    s_load_dwordx2 s[94:95], s[0:1], 72
    v_lshlrev_b32 v1, 2, v0
    v_lshlrev_b32 v2, 3, v0
    v_lshlrev_b32 v3, 4, v0
    v_and_b32 v46, 0x3fc, v1
    v_mov_b64 v[48:49], 0
    v_mov_b64 v[50:51], 0
    v_lshrrev_b32 v62, 6, v0
    v_and_b32 v63, 63, v0
    ds_write_b32 v46, v48 offset:0
    v_readfirstlane_b32 s62, v62
    v_cmp_gt_u32 vcc, 452, v0
    v_mov_b32 v127, v0
    s_movk_i32 s52, 4096
    s_movk_i32 s53, 8192
    s_movk_i32 s54, 16384
    s_mov_b32 s55, 32768
    s_mov_b32 s56, 65536
    s_mov_b32 s57, 49152
    s_mov_b64 s[60:61], vcc
    s_and_b32 s93, s2, 7
    s_lshl_b32 s93, s93, 5
    s_lshr_b32 s3, s2, 3
    s_or_b32 s93, s93, s3
    s_mul_i32 s3, s93, 10000
    s_mul_i32 s58, s93, 20000
    s_mul_i32 s59, s93, 80000
    s_mov_b32 s101, 0
    s_cmp_lt_u32 s2, 4
    s_cselect_b32 s63, s2, 6
    s_cmp_eq_u32 s62, 13
    s_cselect_b32 s63, s63, 6
    s_waitcnt lgkmcnt(0)
    s_add_u32 s24, s6, s3
    s_addc_u32 s25, s7, 0
    s_mov_b32 s26, 10000
    s_mov_b32 s27, 0x20000
    s_cmp_ge_u32 s63, 4
    s_cbranch_scc1 k1_noimg0
    v_and_b32 v64, 31, v63
    v_lshrrev_b32 v65, 5, v63
    v_lshlrev_b32 v64, 2, v64
    s_mov_b32 s48, s16
    s_mov_b32 s49, s17
    s_mov_b32 s50, 8192
    s_mov_b32 s51, 0x20000
    v_lshl_add_u32 v64, v65, 11, v64
    s_and_b32 s64, s63, 1
    s_lshl_b32 s64, s64, 12
    s_lshr_b32 s65, s63, 1
    s_lshl_b32 s65, s65, 7
    s_add_u32 s64, s64, s65
    buffer_load_dword v66, v64, s[48:51], s64 offen offset:0
    buffer_load_dword v67, v64, s[48:51], s64 offen offset:256
    buffer_load_dword v68, v64, s[48:51], s64 offen offset:512
    buffer_load_dword v69, v64, s[48:51], s64 offen offset:768
    buffer_load_dword v70, v64, s[48:51], s64 offen offset:1024
    buffer_load_dword v71, v64, s[48:51], s64 offen offset:1280
    buffer_load_dword v72, v64, s[48:51], s64 offen offset:1536
    buffer_load_dword v73, v64, s[48:51], s64 offen offset:1792
k1_noimg0:
    buffer_load_dword v4, v1, s[24:27], 0 offen nt
    buffer_load_dword v5, v1, s[24:27], s52 offen nt
    buffer_load_dword v6, v1, s[24:27], s53 offen nt
    s_add_u32 s20, s4, s3
    s_addc_u32 s21, s5, 0
    s_mov_b32 s22, 10000
    s_mov_b32 s23, 0x20000
    s_add_u32 s28, s8, s58
    s_addc_u32 s29, s9, 0
    s_mov_b32 s30, 20000
    s_mov_b32 s31, 0x20000
    s_mov_b32 s36, s12
    s_mov_b32 s37, s13
    s_mov_b32 s38, 2048
    s_mov_b32 s39, 0x20000
    s_mov_b32 s40, s14
    s_mov_b32 s41, s15
    s_mov_b32 s42, 128
    s_mov_b32 s43, 0x20000
    buffer_load_dword v7, v1, s[20:23], 0 offen nt
    buffer_load_dword v8, v1, s[20:23], s52 offen nt
    buffer_load_dword v9, v1, s[20:23], s53 offen nt
    v_lshlrev_b32 v61, 4, v63
    s_lshl_b32 s64, s62, 7
    s_add_u32 m0, s64, 37888
    s_mov_b64 exec, 0xff
    buffer_load_dwordx4 v61, s[36:39], s64 offen lds
    s_mov_b32 m0, 39936
    s_nop 0
    buffer_load_dwordx4 v61, s[40:43], 0 offen lds
    s_mov_b64 exec, -1
    buffer_load_dwordx2 v[10:11], v2, s[28:31], 0 offen nt
    buffer_load_dwordx2 v[12:13], v2, s[28:31], s53 offen nt
    buffer_load_dwordx2 v[14:15], v2, s[28:31], s54 offen nt
    s_add_u32 s32, s10, s59
    s_addc_u32 s33, s11, 0
    s_mov_b32 s34, 80000
    s_mov_b32 s35, 0x20000
    ds_write_b128 v3, v[48:51] offset:40960
    s_lshl_b32 s3, s62, 10
    s_add_u32 m0, s3, 81920
    s_lshl_b32 s66, s93, 10
    s_mov_b32 s67, 7168
    v_mov_b32 v47, 1
    v_mov_b32 v60, 268435456
    s_movk_i32 s10, 5000
    s_barrier
    buffer_load_dwordx4 v3, s[32:35], 0 offen nt lds
    s_add_u32 m0, m0, 16384
    s_nop 0
    s_add_u32 s59, s59, 0
    s_add_u32 s36, s18, s59
    s_addc_u32 s37, s19, 0
    s_mov_b32 s38, 80000
    s_mov_b32 s39, 0x20000
    s_mul_i32 s58, s93, 30000
    s_add_u32 s58, s58, 20480000
    s_add_u32 s40, s18, s58
    s_addc_u32 s41, s19, 0
    s_mov_b32 s42, 30000
    s_mov_b32 s43, 0x20000
    s_add_u32 s44, s18, 28160000
    s_addc_u32 s45, s19, 0
    s_mov_b32 s46, 335872
    s_mov_b32 s47, 0x20000
    s_waitcnt vmcnt(9)
    v_mul_u32_u24 v16, 26843, v4
    v_mul_u32_u24 v17, 26843, v5
    v_mul_u32_u24 v18, 26843, v6
    v_lshrrev_b32 v16, 20, v16
    v_lshrrev_b32 v17, 20, v17
    v_lshrrev_b32 v18, 20, v18
    v_lshlrev_b32 v40, 2, v16
    v_lshlrev_b32 v41, 2, v17
    v_lshlrev_b32 v42, 2, v18
    ds_add_rtn_u32 v43, v40, v47 offset:0
    ds_add_rtn_u32 v44, v41, v47 offset:0
    s_mov_b64 exec, s[60:61]
    s_cbranch_execz k1_a
    ds_add_rtn_u32 v45, v42, v47 offset:0
k1_a:
    s_mov_b64 exec, -1
    buffer_load_dwordx4 v3, s[32:35], s54 offen nt lds
    s_add_u32 m0, m0, 16384
    s_nop 0
    buffer_load_dwordx4 v3, s[32:35], s55 offen nt lds
    s_add_u32 m0, m0, 16384
    s_nop 0
    v_mul_u32_u24 v16, 320007, v16
    v_mul_u32_u24 v17, 320007, v17
    v_mul_u32_u24 v18, 320007, v18
    v_add_u32 v16, 8160, v16
    v_add_u32 v17, 8160, v17
    v_add_u32 v18, 8160, v18
    v_lshrrev_b32 v16, 13, v16
    v_lshrrev_b32 v17, 13, v17
    v_lshrrev_b32 v18, 13, v18
    v_sub_u32 v4, v4, v16
    v_sub_u32 v5, v5, v17
    v_sub_u32 v6, v6, v18
    v_lshlrev_b32 v4, 18, v4
    v_lshlrev_b32 v5, 18, v5
    v_lshlrev_b32 v6, 18, v6
    s_waitcnt lgkmcnt(0)
    s_barrier
    ds_read_b128 v[48:51], v61 offset:0
    s_waitcnt vmcnt(8)
    v_cmp_le_u32 s[4:5], s10, v7
    v_cmp_le_u32 s[6:7], s10, v8
    v_cmp_le_u32 s[8:9], s10, v9
    v_cndmask_b32 v16, 0, v60, s[4:5]
    v_cndmask_b32 v17, 0, v60, s[6:7]
    v_cndmask_b32 v18, 0, v60, s[8:9]
    v_or3_b32 v7, v7, v4, v16
    v_or3_b32 v8, v8, v5, v17
    v_or3_b32 v9, v9, v6, v18
    s_waitcnt lgkmcnt(0)
    v_add_u32 v54, v48, v49
    v_add_u32 v55, v54, v50
    v_add_u32 v56, v55, v51
    v_mov_b32 v57, v56
    s_nop 0
    s_nop 0
    v_add_u32_dpp v57, v57, v57 row_shr:1 row_mask:0xf bank_mask:0xf bound_ctrl:1
    s_nop 1
    v_add_u32_dpp v57, v57, v57 row_shr:2 row_mask:0xf bank_mask:0xf bound_ctrl:1
    s_nop 1
    v_add_u32_dpp v57, v57, v57 row_shr:4 row_mask:0xf bank_mask:0xf bound_ctrl:1
    s_nop 1
    v_add_u32_dpp v57, v57, v57 row_shr:8 row_mask:0xf bank_mask:0xf bound_ctrl:1
    s_nop 1
    v_add_u32_dpp v57, v57, v57 row_bcast:15 row_mask:0xa bank_mask:0xf
    s_nop 1
    v_add_u32_dpp v57, v57, v57 row_bcast:31 row_mask:0xc bank_mask:0xf
    s_nop 1
    v_sub_u32 v52, v57, v56
    v_add_u32 v53, v52, v48
    v_add_u32 v54, v52, v54
    v_add_u32 v55, v52, v55
    ds_write_b128 v61, v[52:55] offset:1024
    ds_read_b32 v56, v40 offset:1024
    ds_read_b32 v57, v41 offset:1024
    ds_read_b32 v58, v42 offset:1024
    v_lshl_or_b32 v48, v48, 16, v52
    v_lshl_or_b32 v49, v49, 16, v53
    v_lshl_or_b32 v50, v50, 16, v54
    v_lshl_or_b32 v51, v51, 16, v55
    v_add_u32 v17, 1024, v0
    v_add_u32 v18, 2048, v0
    s_waitcnt lgkmcnt(0)
    v_add_u32 v43, v43, v56
    v_add_u32 v44, v44, v57
    v_add_u32 v45, v45, v58
    v_mad_u32_u24 v40, v43, 12, s67
    v_lshlrev_b32 v43, 1, v43
    v_mad_u32_u24 v41, v44, 12, s67
    v_lshlrev_b32 v44, 1, v44
    v_mad_u32_u24 v42, v45, 12, s67
    v_lshlrev_b32 v45, 1, v45
    ds_write_b16 v43, v0 offset:2048
    ds_write_b16 v44, v17 offset:2048
    s_waitcnt vmcnt(3)
    ds_write2_b32 v40, v10, v11 offset0:0 offset1:1
    ds_write_b32 v40, v7 offset:8
    ds_write2_b32 v41, v12, v13 offset0:0 offset1:1
    ds_write_b32 v41, v8 offset:8
    s_mov_b64 exec, s[60:61]
    s_cbranch_execz k1_b
    ds_write_b16 v45, v18 offset:2048
    ds_write2_b32 v42, v14, v15 offset0:0 offset1:1
    ds_write_b32 v42, v9 offset:8
k1_b:
    s_mov_b64 exec, -1
    s_cmp_lg_u32 s62, 0
    s_cbranch_scc1 k1_c
    buffer_store_dwordx4 v[48:51], v61, s[44:47], s66 offen sc1
    s_and_b32 s4, s2, 7
    s_lshl_b32 s4, s4, 5
    s_lshr_b32 s5, s2, 3
    s_or_b32 s4, s4, s5
    s_and_b32 s5, s4, 15
    s_lshl_b32 s5, s5, 2
    s_lshr_b32 s4, s4, 4
    s_mul_i32 s4, s4, 128
    s_add_u32 s4, s4, s5
    s_add_u32 s4, s4, 270336
    v_lshlrev_b32 v64, 15, v63
    v_mov_b32 v65, 0
    s_mov_b64 exec, 1
    buffer_store_dword v65, v64, s[44:47], s4 offen sc1
    s_mov_b64 exec, 0xffff
    v_and_b32 v66, 63, v127
    v_mov_b32 v67, 0
    v_mul_u32_u24 v66, 1024, v66
    s_mov_b32 s4, s2
    s_lshl_b32 s4, s4, 2
    s_add_u32 s4, s4, 303104
    buffer_store_dword v67, v66, s[44:47], s4 offen sc1
    s_mov_b64 exec, -1
k1_c:
    buffer_load_dwordx4 v3, s[32:35], s57 offen nt lds
    s_add_u32 m0, m0, 16384
    s_nop 0
    v_and_b32 v1, -2, v0
    v_and_b32 v2, 1, v0
    v_lshlrev_b32 v2, 4, v2
    v_add_u32 v2, 81920, v2
    v_and_b32 v4, 31, v63
    v_lshrrev_b32 v5, 5, v63
    v_lshlrev_b32 v4, 2, v4
    v_lshl_add_u32 v4, v5, 10, v4
    v_add_u32 v4, 37888, v4
    s_and_b32 s3, s62, 3
    v_and_b32 v38, -2, v63
    s_lshl_b32 s3, s3, 10
    v_add_u32 v38, s3, v38
    s_waitcnt lgkmcnt(0)
    s_barrier
    ds_read_b128 v[24:27], v3 offset:7168
    ds_read_b128 v[28:31], v3 offset:23552
    ds_read_u16 v32, v1 offset:2048
    ds_read_u16 v33, v1 offset:3072
    ds_read_u16 v34, v1 offset:4096
    ds_read_u16 v35, v1 offset:5120
    ds_read_u16 v36, v1 offset:6144
    ds_read_u16 v37, v38 offset:3008
    ds_read2_b32 v[104:105], v4 offset0:0 offset1:32
    ds_read2_b32 v[106:107], v4 offset0:64 offset1:96
    ds_read2_b32 v[108:109], v4 offset0:128 offset1:160
    ds_read2_b32 v[110:111], v4 offset0:192 offset1:224
    s_waitcnt lgkmcnt(11)
    buffer_store_dwordx4 v[24:27], v3, s[40:43], 0 offen sc1
    s_waitcnt lgkmcnt(10)
    buffer_store_dwordx4 v[28:31], v3, s[40:43], s54 offen sc1
    s_barrier
    buffer_load_dwordx4 v3, s[32:35], s56 offen nt lds
    s_add_u32 s24, s18, 28160000
    s_addc_u32 s25, s19, 0
    s_mov_b32 s26, 335872
    s_mov_b32 s27, 0x20000
    s_mov_b32 s48, s94
    s_mov_b32 s49, s95
    s_mov_b32 s50, 256
    s_mov_b32 s51, 0x20000
    s_cmp_lg_u32 s62, 12
    s_cbranch_scc1 k1_nocg
    v_and_b32 v64, 3, v63
    v_lshlrev_b32 v64, 1, v64
    s_waitcnt lgkmcnt(0)
    ds_read_u16 v66, v64 offset:39936
    ds_read_u16 v67, v64 offset:39944
    ds_read_u16 v68, v64 offset:39952
    ds_read_u16 v69, v64 offset:39960
    ds_read_u16 v70, v64 offset:39968
    ds_read_u16 v71, v64 offset:39976
    ds_read_u16 v72, v64 offset:39984
    ds_read_u16 v73, v64 offset:39992
    s_waitcnt lgkmcnt(0)
    ds_read_u16 v74, v64 offset:40000
    ds_read_u16 v75, v64 offset:40008
    ds_read_u16 v76, v64 offset:40016
    ds_read_u16 v77, v64 offset:40024
    ds_read_u16 v78, v64 offset:40032
    ds_read_u16 v79, v64 offset:40040
    ds_read_u16 v80, v64 offset:40048
    ds_read_u16 v81, v64 offset:40056
    s_waitcnt lgkmcnt(0)
    v_lshl_or_b32 v84, v67, 16, v66
    v_lshl_or_b32 v85, v69, 16, v68
    v_lshl_or_b32 v86, v71, 16, v70
    v_lshl_or_b32 v87, v73, 16, v72
    v_lshl_or_b32 v88, v75, 16, v74
    v_lshl_or_b32 v89, v77, 16, v76
    v_lshl_or_b32 v90, v79, 16, v78
    v_lshl_or_b32 v91, v81, 16, v80
    v_add_u32 v64, 75968, v61
    s_mov_b64 exec, 15
    ds_write_b128 v64, v[84:87]
    ds_write_b128 v64, v[88:91] offset:64
    s_mov_b64 exec, -1
k1_nocg:
    s_mov_b32 s4, 0xbfb8aa3b
    s_mov_b32 s5, 0xffff0000
    s_waitcnt lgkmcnt(0)
    v_lshl_add_u32 v32, v32, 5, v2
    v_lshl_add_u32 v33, v33, 5, v2
    v_lshl_add_u32 v34, v34, 5, v2
    v_lshl_add_u32 v35, v35, 5, v2
    v_lshl_add_u32 v36, v36, 5, v2
    v_lshl_add_u32 v37, v37, 5, v2
    v_lshlrev_b32 v76, 16, v104
    v_lshlrev_b32 v77, 16, v105
    v_mul_f32 v76, s4, v76
    v_mul_f32 v77, s4, v77
    v_cvt_pk_bf16_f32 v92, v76, v77
    v_lshlrev_b32 v76, 16, v106
    v_lshlrev_b32 v77, 16, v107
    v_mul_f32 v76, s4, v76
    v_mul_f32 v77, s4, v77
    v_cvt_pk_bf16_f32 v93, v76, v77
    v_lshlrev_b32 v76, 16, v108
    v_lshlrev_b32 v77, 16, v109
    v_mul_f32 v76, s4, v76
    v_mul_f32 v77, s4, v77
    v_cvt_pk_bf16_f32 v94, v76, v77
    v_lshlrev_b32 v76, 16, v110
    v_lshlrev_b32 v77, 16, v111
    v_mul_f32 v76, s4, v76
    v_mul_f32 v77, s4, v77
    v_cvt_pk_bf16_f32 v95, v76, v77
    v_and_b32 v76, s5, v104
    v_and_b32 v77, s5, v105
    v_mul_f32 v76, s4, v76
    v_mul_f32 v77, s4, v77
    v_cvt_pk_bf16_f32 v96, v76, v77
    v_and_b32 v76, s5, v106
    v_and_b32 v77, s5, v107
    v_mul_f32 v76, s4, v76
    v_mul_f32 v77, s4, v77
    v_cvt_pk_bf16_f32 v97, v76, v77
    v_and_b32 v76, s5, v108
    v_and_b32 v77, s5, v109
    v_mul_f32 v76, s4, v76
    v_mul_f32 v77, s4, v77
    v_cvt_pk_bf16_f32 v98, v76, v77
    v_and_b32 v76, s5, v110
    v_and_b32 v77, s5, v111
    v_mul_f32 v76, s4, v76
    v_mul_f32 v77, s4, v77
    v_cvt_pk_bf16_f32 v99, v76, v77
    s_waitcnt vmcnt(1)
    s_barrier
    s_cmp_lg_u32 s62, 0
    s_cbranch_scc1 k1_e0
    v_mov_b32 v64, 1
    s_mul_i32 s3, s2, 171
    s_lshr_b32 s3, s3, 9
    s_mul_i32 s3, s3, 3
    s_sub_u32 s3, s2, s3
    s_lshl_b32 s3, s3, 6
    s_cmp_eq_u32 s3, 128
    s_cselect_b32 s3, 192, s3
    s_mov_b64 exec, 1
    buffer_atomic_add v64, off, s[48:51], s3 sc1
    s_mov_b64 exec, -1
    s_waitcnt vmcnt(1)
    s_branch k1_e1
k1_e0:
    s_waitcnt vmcnt(0)
k1_e1:
    s_barrier
    s_cmp_eq_u32 s62, 15
    s_cbranch_scc1 k1_fw
    ds_read_b128 v[4:7], v32
    ds_read_b128 v[8:11], v33
    ds_read_b128 v[12:15], v34
    ds_read_b128 v[16:19], v35
    ds_read_b128 v[20:23], v36
    ds_read_b128 v[24:27], v37
    v_mov_b32 v64, 1
    s_waitcnt lgkmcnt(5)
    buffer_store_dwordx4 v[4:7], v3, s[36:39], 0 offen sc1
    s_waitcnt lgkmcnt(4)
    buffer_store_dwordx4 v[8:11], v3, s[36:39], s54 offen sc1
    s_waitcnt lgkmcnt(3)
    buffer_store_dwordx4 v[12:15], v3, s[36:39], s55 offen sc1
    s_waitcnt lgkmcnt(2)
    buffer_store_dwordx4 v[16:19], v3, s[36:39], s57 offen sc1
    s_waitcnt lgkmcnt(1)
    buffer_store_dwordx4 v[20:23], v3, s[36:39], s56 offen sc1
    s_lshr_b32 s3, s62, 2
    s_cmp_lg_u32 s3, 1
    s_cbranch_scc1 k1_fw
    s_and_b32 s3, s62, 3
    s_lshl_b32 s3, s3, 14
    s_add_u32 s3, s3, 15360
    s_waitcnt lgkmcnt(0)
    buffer_store_dwordx4 v[24:27], v61, s[36:39], s3 offen sc1
k1_fw:
    s_cmp_ge_u32 s63, 4
    s_cbranch_scc1 k1_arr
    s_mov_b32 s4, 0x05040100
    s_mov_b32 s5, 0x07060302
    s_lshl_b32 s58, s63, 11
    s_add_u32 s58, s58, 262144
    v_perm_b32 v84, v67, v66, s4
    v_perm_b32 v88, v67, v66, s5
    v_perm_b32 v85, v69, v68, s4
    v_perm_b32 v89, v69, v68, s5
    v_perm_b32 v86, v71, v70, s4
    v_perm_b32 v90, v71, v70, s5
    v_perm_b32 v87, v73, v72, s4
    v_perm_b32 v91, v73, v72, s5
    buffer_store_dwordx4 v[84:87], v61, s[44:47], s58 offen sc1
    buffer_store_dwordx4 v[88:91], v61, s[44:47], s58 offen offset:1024 sc1
k1_arr:
    v_mov_b64 v[40:41], 0
    v_mov_b64 v[42:43], 0
    v_mov_b32 v44, 163136
    ds_write_b128 v3, v[40:43] offset:0
    ds_write_b128 v3, v[40:43] offset:16384
    s_cmp_ge_u32 s62, 8
    s_cbranch_scc1 k1_z
    ds_write_b128 v3, v[40:43] offset:32768
k1_z:
    s_mov_b64 exec, 1
    ds_write_b128 v44, v[40:43]
    ds_write_b128 v44, v[40:43] offset:16
    s_mov_b64 exec, -1
    v_and_b32 v122, 63, v0
    s_mov_b32 s32, s62
    s_and_b32 s3, s2, 7
    s_lshl_b32 s3, s3, 5
    s_lshr_b32 s10, s2, 3
    s_or_b32 s3, s3, s10
    s_lshl_b32 s33, s3, 2
    s_mul_i32 s34, s3, 320007
    s_add_u32 s10, s34, 328167
    s_add_u32 s34, s34, 8160
    s_lshr_b32 s34, s34, 13
    s_lshr_b32 s10, s10, 13
    s_min_u32 s10, s10, 10000
    s_sub_u32 s10, s10, s34
    s_lshl_b32 s10, s10, 9
    s_lshl_b32 s11, s34, 9
    s_mov_b32 s35, 0
    s_mov_b32 s40, 1.0
    s_mov_b32 s41, 1.0
    s_mov_b32 s42, 10000
    s_movk_i32 s93, 512
    s_mov_b64 s[8:9], s[18:19]
    s_mov_b32 s12, s68
    s_or_b32 s13, s69, 33554432
    s_mov_b32 s14, 10000
    s_mov_b32 s15, 0x20000
    s_add_u32 s28, s70, s11
    s_addc_u32 s29, s71, 0
    s_mov_b32 s30, s10
    s_mov_b32 s31, 0x20000
    s_add_u32 s20, s8, 20480000
    s_addc_u32 s21, s9, 0
    s_mov_b32 s22, 7680000
    s_mov_b32 s23, 0x20000
    s_add_u32 s16, s8, 0
    s_addc_u32 s17, s9, 0
    s_mov_b32 s18, 20480000
    s_mov_b32 s19, 0x20000
    s_waitcnt vmcnt(0)
    v_mov_b32 v64, 1
    v_mov_b32 v65, 52484
    s_mov_b64 exec, 1
    ds_add_rtn_u32 v65, v65, v64
    s_waitcnt lgkmcnt(0)
    v_readfirstlane_b32 s3, v65
    s_cmp_lg_u32 s3, 15
    s_cbranch_scc1 k2_ns
    s_mov_b64 exec, 0xffff
    v_and_b32 v65, 63, v127
    v_mov_b32 v64, 1
    v_mul_u32_u24 v65, 1024, v65
    s_mov_b32 s3, s2
    s_lshl_b32 s3, s3, 2
    s_add_u32 s3, s3, 303104
    buffer_store_dword v64, v65, s[24:27], s3 offen sc1
k2_ns:
    s_mov_b64 exec, -1
    s_cmp_lg_u32 s32, 15
    s_cbranch_scc1 k2_p1
    s_cmp_ge_u32 s2, 8
    s_cbranch_scc1 k2_mb
    v_and_b32 v65, 63, v127
    v_mul_u32_u24 v65, 64, v65
    s_mov_b64 exec, 11
k2_wt:
    buffer_load_dword v88, v65, s[48:51], 0 offen sc1
    s_add_u32 s101, s101, 1
    s_sleep 2
    s_waitcnt vmcnt(0)
    v_readlane_b32 s3, v88, 0
    v_readlane_b32 s10, v88, 1
    s_add_u32 s3, s3, s10
    v_readlane_b32 s10, v88, 3
    s_add_u32 s3, s3, s10
    s_cmp_ge_u32 s3, 256
    s_cbranch_scc1 k2_wtd
    s_cmp_lt_u32 s101, 100000
    s_cbranch_scc1 k2_wt
k2_wtd:
    s_mov_b64 exec, -1
    s_mov_b32 s10, 270336
    v_and_b32 v65, 63, v127
    v_mov_b32 v64, 1
    v_and_b32 v66, 3, v65
    v_lshrrev_b32 v65, 2, v65
    v_mul_u32_u24 v65, 128, v65
    v_lshl_add_u32 v68, v66, 4, v65
    v_mov_b32 v65, 1
    v_mov_b32 v66, 1
    v_mov_b32 v67, 1
    buffer_store_dwordx4 v[64:67], v68, s[24:27], s10 offen sc1
    s_branch k2_tg
k2_mb:
    s_and_b32 s3, s2, 7
    s_lshl_b32 s3, s3, 5
    s_lshr_b32 s10, s2, 3
    s_or_b32 s3, s3, s10
    s_and_b32 s10, s3, 15
    s_lshl_b32 s10, s10, 2
    s_lshr_b32 s3, s3, 4
    s_mul_i32 s3, s3, 128
    s_add_u32 s3, s3, s10
    s_add_u32 s3, s3, 270336
    v_mov_b32 v88, 0
    s_mov_b64 exec, 1
k2_pl1:
    buffer_load_dword v88, off, s[24:27], s3 sc1
    s_add_u32 s101, s101, 1
    s_waitcnt vmcnt(0)
    v_readfirstlane_b32 s10, v88
    s_cmp_eq_u32 s10, 1
    s_cbranch_scc1 k2_pl1d
    s_cmp_ge_u32 s101, 100000
    s_cbranch_scc1 k2_pl1d
    s_sleep 8
    s_branch k2_pl1
k2_pl1d:
    s_mov_b64 exec, -1
k2_tg:
    v_lshlrev_b32 v28, 12, v122
    buffer_load_dword v24, v28, s[24:27], s33 offen offset:0 sc1
    buffer_load_dword v25, v28, s[24:27], s33 offen offset:1024 sc1
    buffer_load_dword v26, v28, s[24:27], s33 offen offset:2048 sc1
    buffer_load_dword v27, v28, s[24:27], s33 offen offset:3072 sc1
k2_tw:
    v_mul_u32_u24 v12, 10000, v122
    v_add_u32 v13, 2500, v12
    v_add_u32 v14, 5000, v12
    v_add_u32 v15, 7500, v12
    v_lshlrev_b32 v19, 4, v122
    v_lshlrev_b32 v18, 2, v122
    v_add_u32 v19, 76096, v19
    v_add_u32 v18, 76096, v18
    s_waitcnt vmcnt(0)
    v_lshrrev_b32 v4, 16, v24
    v_lshrrev_b32 v5, 16, v25
    v_lshrrev_b32 v6, 16, v26
    v_lshrrev_b32 v7, 16, v27
    v_add_u32 v10, v4, v5
    v_add_u32 v11, v10, v6
    v_add_u32 v16, v11, v7
    v_mov_b32 v17, v16
    v_and_b32 v0, 0xffff, v24
    v_and_b32 v1, 0xffff, v25
    v_add_u32_dpp v17, v17, v17 row_shr:1 row_mask:0xf bank_mask:0xf bound_ctrl:1
    v_and_b32 v2, 0xffff, v26
    v_and_b32 v3, 0xffff, v27
    v_add_u32_dpp v17, v17, v17 row_shr:2 row_mask:0xf bank_mask:0xf bound_ctrl:1
    v_add_u32 v12, v12, v0
    v_add_u32 v13, v13, v1
    v_add_u32_dpp v17, v17, v17 row_shr:4 row_mask:0xf bank_mask:0xf bound_ctrl:1
    v_add_u32 v14, v14, v2
    v_add_u32 v15, v15, v3
    v_add_u32_dpp v17, v17, v17 row_shr:8 row_mask:0xf bank_mask:0xf bound_ctrl:1
    s_nop 1
    v_add_u32_dpp v17, v17, v17 row_bcast:15 row_mask:0xa bank_mask:0xf
    s_nop 1
    v_add_u32_dpp v17, v17, v17 row_bcast:31 row_mask:0xc bank_mask:0xf
    s_nop 1
    v_sub_u32 v8, v17, v16
    ds_write_b32 v18, v17 offset:2048
    v_add_u32 v9, v8, v4
    v_add_u32 v10, v8, v10
    v_add_u32 v11, v8, v11
    v_sub_u32 v12, v12, v8
    v_sub_u32 v13, v13, v9
    v_sub_u32 v14, v14, v10
    v_sub_u32 v15, v15, v11
    ds_write_b128 v19, v[8:11]
    v_subrev_u32 v4, s35, v8
    v_subrev_u32 v5, s35, v9
    v_subrev_u32 v6, s35, v10
    v_subrev_u32 v7, s35, v11
    ds_write_b128 v19, v[12:15] offset:1024
    v_min_u32 v4, 2720, v4
    v_min_u32 v5, 2720, v5
    v_min_u32 v6, 2720, v6
    v_min_u32 v7, 2720, v7
    v_lshlrev_b32 v4, 2, v4
    v_lshlrev_b32 v5, 2, v5
    v_lshlrev_b32 v6, 2, v6
    v_lshlrev_b32 v7, 2, v7
    ds_max_u32 v4, v12 offset:40960
    ds_max_u32 v5, v13 offset:40960
    ds_max_u32 v6, v14 offset:40960
    ds_max_u32 v7, v15 offset:40960
k2_p1:
    s_mul_i32 s58, s32, 170
    v_lshlrev_b32 v4, 4, v122
    v_add_u32 v16, s58, v122
    v_mov_b32 v19, 78396
    v_add_u32 v4, 76096, v4
    v_lshlrev_b32 v5, 2, v16
    v_add_u32 v17, 64, v16
    v_add_u32 v18, 128, v16
    s_add_u32 s59, s58, s35
    s_add_u32 s10, s58, 170
    s_waitcnt lgkmcnt(0)
    s_barrier
    ds_read_b128 v[8:11], v4
    ds_read_b32 v19, v19
    ds_read_b128 v[12:15], v4 offset:1024
    ds_read_b32 v0, v5 offset:40960
    ds_read_b32 v1, v5 offset:41216
    ds_read_b32 v2, v5 offset:41472
    s_waitcnt lgkmcnt(5)
    v_cmp_ge_u32 s[62:63], s59, v8
    v_cmp_ge_u32 s[64:65], s59, v9
    v_cmp_ge_u32 s[66:67], s59, v10
    v_cmp_ge_u32 s[68:69], s59, v11
    s_waitcnt lgkmcnt(3)
    v_readfirstlane_b32 s36, v19
    v_cndmask_b32 v4, 0, v12, s[62:63]
    v_cndmask_b32 v5, 0, v13, s[64:65]
    v_cndmask_b32 v6, 0, v14, s[66:67]
    v_cndmask_b32 v7, 0, v15, s[68:69]
    s_sub_u32 s37, s36, s35
    s_min_u32 s37, s37, 2720
    s_min_u32 s10, s10, s37
    v_max3_u32 v4, v4, v5, v6
    v_max_u32 v3, v4, v7
    v_cmp_gt_u32 s[52:53], s10, v16
    v_cmp_gt_u32 s[54:55], s10, v17
    v_cmp_gt_u32 s[56:57], s10, v18
    s_waitcnt lgkmcnt(0)
    v_max_u32_dpp v3, v3, v3 row_shr:1 row_mask:0xf bank_mask:0xf bound_ctrl:1
    v_max_u32_dpp v0, v0, v0 row_shr:1 row_mask:0xf bank_mask:0xf bound_ctrl:1
    v_max_u32_dpp v1, v1, v1 row_shr:1 row_mask:0xf bank_mask:0xf bound_ctrl:1
    v_max_u32_dpp v2, v2, v2 row_shr:1 row_mask:0xf bank_mask:0xf bound_ctrl:1
    v_max_u32_dpp v3, v3, v3 row_shr:2 row_mask:0xf bank_mask:0xf bound_ctrl:1
    v_max_u32_dpp v0, v0, v0 row_shr:2 row_mask:0xf bank_mask:0xf bound_ctrl:1
    v_max_u32_dpp v1, v1, v1 row_shr:2 row_mask:0xf bank_mask:0xf bound_ctrl:1
    v_max_u32_dpp v2, v2, v2 row_shr:2 row_mask:0xf bank_mask:0xf bound_ctrl:1
    v_max_u32_dpp v3, v3, v3 row_shr:4 row_mask:0xf bank_mask:0xf bound_ctrl:1
    v_max_u32_dpp v0, v0, v0 row_shr:4 row_mask:0xf bank_mask:0xf bound_ctrl:1
    v_max_u32_dpp v1, v1, v1 row_shr:4 row_mask:0xf bank_mask:0xf bound_ctrl:1
    v_max_u32_dpp v2, v2, v2 row_shr:4 row_mask:0xf bank_mask:0xf bound_ctrl:1
    v_max_u32_dpp v3, v3, v3 row_shr:8 row_mask:0xf bank_mask:0xf bound_ctrl:1
    v_max_u32_dpp v0, v0, v0 row_shr:8 row_mask:0xf bank_mask:0xf bound_ctrl:1
    v_max_u32_dpp v1, v1, v1 row_shr:8 row_mask:0xf bank_mask:0xf bound_ctrl:1
    v_max_u32_dpp v2, v2, v2 row_shr:8 row_mask:0xf bank_mask:0xf bound_ctrl:1
    v_max_u32_dpp v3, v3, v3 row_bcast:15 row_mask:0xa bank_mask:0xf
    v_max_u32_dpp v0, v0, v0 row_bcast:15 row_mask:0xa bank_mask:0xf
    v_max_u32_dpp v1, v1, v1 row_bcast:15 row_mask:0xa bank_mask:0xf
    v_max_u32_dpp v2, v2, v2 row_bcast:15 row_mask:0xa bank_mask:0xf
    v_max_u32_dpp v3, v3, v3 row_bcast:31 row_mask:0xc bank_mask:0xf
    v_max_u32_dpp v0, v0, v0 row_bcast:31 row_mask:0xc bank_mask:0xf
    v_max_u32_dpp v1, v1, v1 row_bcast:31 row_mask:0xc bank_mask:0xf
    v_max_u32_dpp v2, v2, v2 row_bcast:31 row_mask:0xc bank_mask:0xf
    v_readlane_b32 s62, v3, 63
    v_readlane_b32 s63, v0, 63
    v_readlane_b32 s64, v1, 63
    v_lshrrev_b32 v7, 1, v122
    v_lshlrev_b32 v7, 2, v7
    v_add_u32 v8, 128, v7
    s_max_u32 s63, s63, s62
    s_max_u32 s64, s64, s63
    v_max_u32 v0, s62, v0
    v_max_u32 v1, s63, v1
    v_max_u32 v2, s64, v2
    v_mov_b32 v3, 0xf00000
    v_add3_u32 v0, v0, v16, s35
    v_add3_u32 v1, v1, v17, s35
    v_add3_u32 v2, v2, v18, s35
    v_cndmask_b32 v0, v3, v0, s[52:53]
    v_cndmask_b32 v1, v3, v1, s[54:55]
    v_cndmask_b32 v2, v3, v2, s[56:57]
    v_mul_u32_u24 v4, 12, v0
    v_mul_u32_u24 v5, 12, v1
    v_mul_u32_u24 v6, 12, v2
    buffer_load_dwordx3 v[20:22], v4, s[20:23], 0 offen sc1
    buffer_load_dwordx3 v[24:26], v5, s[20:23], 0 offen sc1
    buffer_load_dwordx3 v[28:30], v6, s[20:23], 0 offen sc1
    ds_bpermute_b32 v32, v7, v0
    ds_bpermute_b32 v33, v8, v0
    ds_bpermute_b32 v34, v7, v1
    ds_bpermute_b32 v35, v8, v1
    ds_bpermute_b32 v36, v7, v2
    ds_bpermute_b32 v37, v8, v2
    v_and_b32 v9, 1, v122
    v_lshlrev_b32 v9, 4, v9
    s_lshl_b32 s3, s58, 5
    s_add_u32 m0, s3, 76096
    v_mov_b32 v62, 1
    s_waitcnt lgkmcnt(0)
    v_lshl_or_b32 v32, v32, 5, v9
    v_lshl_or_b32 v33, v33, 5, v9
    v_lshl_or_b32 v34, v34, 5, v9
    v_lshl_or_b32 v35, v35, 5, v9
    v_lshl_or_b32 v36, v36, 5, v9
    v_lshl_or_b32 v37, v37, 5, v9
    s_waitcnt vmcnt(0)
    v_lshrrev_b32 v40, 24, v22
    v_lshrrev_b32 v41, 24, v26
    v_lshrrev_b32 v42, 24, v30
    v_bfe_u32 v56, v22, 16, 8
    v_bfe_u32 v57, v26, 16, 8
    v_bfe_u32 v58, v30, 16, 8
    v_lshlrev_b32 v44, v40, v62
    v_lshlrev_b32 v45, v41, v62
    v_lshlrev_b32 v46, v42, v62
    s_mov_b64 exec, s[52:53]
    s_cbranch_execz k2_h
    ds_add_rtn_u32 v59, v56, v44 offset:52224
    s_mov_b64 exec, s[54:55]
    s_cbranch_execz k2_h
    ds_add_rtn_u32 v60, v57, v45 offset:52224
    s_mov_b64 exec, s[56:57]
    s_cbranch_execz k2_h
    ds_add_rtn_u32 v61, v58, v46 offset:52224
k2_h:
    s_mov_b64 exec, -1
    s_mov_b32 s3, 0x05040100
    v_perm_b32 v22, v16, v22, s3
    v_perm_b32 v26, v17, v26, s3
    v_perm_b32 v30, v18, v30, s3
    v_lshlrev_b32 v0, 2, v122
    s_mov_b32 s51, 75968
    s_cmp_lg_u32 s32, 15
    s_cbranch_scc1 k2_np2
    s_cmp_lg_u32 s35, 0
    s_cbranch_scc1 k2_np2
    s_and_b32 s3, s2, 7
    s_lshl_b32 s3, s3, 5
    s_lshr_b32 s10, s2, 3
    s_or_b32 s3, s3, s10
    s_lshr_b32 s3, s3, 4
    s_mul_i32 s3, s3, 1024
    s_add_u32 s3, s3, 303104
    v_and_b32 v91, 63, v127
    s_mov_b32 s10, 1
    v_lshlrev_b32 v100, 4, v91
k2_pl2:
    buffer_load_dwordx4 v[88:91], v100, s[24:27], s3 offen sc1
    s_add_u32 s101, s101, 1
    s_waitcnt vmcnt(0)
    v_and_b32 v88, v88, v89
    v_and_b32 v88, v88, v90
    v_and_b32 v88, v88, v91
    v_cmp_ne_u32 vcc, s10, v88
    s_cbranch_vccz k2_pl2d
    s_cmp_ge_u32 s101, 100000
    s_cbranch_scc1 k2_pl2d
    s_sleep 4
    s_branch k2_pl2
k2_pl2d:
    s_mov_b64 exec, -1
k2_np2:
    s_waitcnt lgkmcnt(0)
    s_barrier
    buffer_load_dwordx4 v32, s[16:19], 0 offen sc1 lds
    s_add_u32 m0, m0, 1024
    s_nop 0
    buffer_load_dwordx4 v33, s[16:19], 0 offen sc1 lds
    s_add_u32 m0, m0, 1024
    s_nop 0
    ds_read_b32 v64, v0 offset:52224
    s_mov_b32 s62, 5632
    v_bfe_u32 v59, v59, v40, 16
    v_bfe_u32 v60, v60, v41, 16
    v_bfe_u32 v61, v61, v42, 16
    v_and_b32 v10, 31, v122
    v_lshrrev_b32 v11, 5, v122
    s_waitcnt lgkmcnt(0)
    v_add_u32 v65, 0x10001, v64
    v_and_b32 v65, 0xfffefffe, v65
    v_mov_b32 v66, v65
    v_and_b32 v68, 0xffff, v64
    v_and_b32 v70, 0xffff, v65
    v_add_u32_dpp v66, v66, v66 row_shr:1 row_mask:0xf bank_mask:0xf bound_ctrl:1
    s_nop 1
    v_add_u32_dpp v66, v66, v66 row_shr:2 row_mask:0xf bank_mask:0xf bound_ctrl:1
    s_nop 1
    v_add_u32_dpp v66, v66, v66 row_shr:4 row_mask:0xf bank_mask:0xf bound_ctrl:1
    s_nop 1
    v_add_u32_dpp v66, v66, v66 row_shr:8 row_mask:0xf bank_mask:0xf bound_ctrl:1
    s_nop 1
    v_add_u32_dpp v66, v66, v66 row_bcast:15 row_mask:0xa bank_mask:0xf
    s_nop 1
    v_add_u32_dpp v66, v66, v66 row_bcast:31 row_mask:0xc bank_mask:0xf
    s_nop 1
    v_sub_u32 v67, v66, v65
    v_readlane_b32 s38, v66, 63
    v_lshrrev_b32 v69, 16, v64
    v_lshrrev_b32 v71, 16, v65
    s_nop 0
    s_and_b32 s4, s38, 0xffff
    s_lshr_b32 s5, s38, 16
    s_add_u32 s4, s4, 7
    s_add_u32 s5, s5, 7
    s_lshr_b32 s4, s4, 3
    s_lshr_b32 s5, s5, 3
    v_mov_b32 v12, 0
    s_lshl_b32 s3, s4, 19
    v_add_u32 v67, s3, v67
    ds_write_b32 v0, v12 offset:52480
    ds_bpermute_b32 v0, v56, v67
    ds_bpermute_b32 v1, v57, v67
    ds_bpermute_b32 v2, v58, v67
    s_lshr_b32 s6, s4, 4
    s_lshr_b32 s7, s5, 4
    s_and_b32 s3, s4, 15
    s_mul_i32 s63, s6, s32
    s_min_u32 s10, s3, s32
    s_add_u32 s63, s63, s10
    s_cmp_lt_u32 s32, s3
    s_addc_u32 s64, s6, 0
    s_and_b32 s3, s5, 15
    s_add_u32 s3, s3, s32
    s_mul_i32 s65, s7, s32
    s_sub_u32 s10, s3, 16
    s_max_i32 s10, s10, 0
    s_add_u32 s65, s65, s10
    s_cmp_ge_u32 s3, 16
    s_addc_u32 s66, s7, 0
    s_add_u32 s39, s64, s66
    s_add_u32 s3, s4, s65
    s_add_u32 s10, s63, s64
    s_sub_u32 s10, s10, s4
    s_lshl_b32 s10, s10, 3
    s_lshl_b32 s11, s65, 3
    s_bfm_b64 s[68:69], s64, 0
    s_bfm_b64 vcc, s66, 32
    s_mov_b64 exec, 0xffffffff
    v_add_u32 v12, s63, v10
    v_mov_b32 v13, s11
    s_not_b64 exec, exec
    v_add_u32 v12, s3, v10
    v_mov_b32 v13, s10
    s_mov_b64 exec, -1
    v_lshlrev_b32 v12, 1, v12
    s_or_b64 exec, vcc, s[68:69]
    s_cbranch_execz k2_nosh
    ds_write_b16 v12, v13 offset:52736
k2_nosh:
    s_mov_b64 exec, -1
    s_waitcnt lgkmcnt(0)
    v_bfe_u32 v0, v0, v40, 16
    v_bfe_u32 v1, v1, v41, 16
    v_bfe_u32 v2, v2, v42, 16
    v_add_u32 v0, v0, v59
    v_add_u32 v1, v1, v60
    v_add_u32 v2, v2, v61
    s_mov_b64 s[6:7], 0
    s_cmp_lt_u32 s32, 14
    s_cbranch_scc1 k2_nopad0
    s_sub_u32 s3, s32, 14
    s_mul_i32 s10, s3, s5
    s_add_u32 s10, s10, s4
    s_lshl_b32 s10, s10, 3
    s_lshl_b32 s3, s3, 4
    v_bfe_u32 v12, v64, s3, 16
    v_bfe_u32 v13, v67, s3, 16
    v_subrev_u32 v14, 40, v122
    v_cmp_gt_u32 vcc, 8, v14
    v_max_i32 v14, 0, v14
    v_add3_u32 v3, v12, v13, v14
    v_and_b32 v12, 1, v12
    v_cmp_gt_u32 s[68:69], s10, v3
    v_cmp_eq_u32 s[6:7], 1, v12
    s_and_b64 vcc, vcc, s[68:69]
    s_or_b64 s[6:7], s[6:7], vcc
k2_nopad0:
    v_lshrrev_b32 v4, 2, v0
    v_lshrrev_b32 v5, 2, v1
    v_lshrrev_b32 v6, 2, v2
    v_lshrrev_b32 v7, 2, v3
    v_and_b32 v4, 0x7fe, v4
    v_and_b32 v5, 0x7fe, v5
    v_and_b32 v6, 0x7fe, v6
    v_and_b32 v7, 0x7fe, v7
    s_barrier
    ds_read_i16 v4, v4 offset:52736
    ds_read_i16 v5, v5 offset:52736
    ds_read_i16 v6, v6 offset:52736
    ds_read_i16 v7, v7 offset:52736
    buffer_load_dwordx4 v34, s[16:19], 0 offen sc1 lds
    s_add_u32 m0, m0, 1024
    s_nop 0
    buffer_load_dwordx4 v35, s[16:19], 0 offen sc1 lds
    s_add_u32 m0, m0, 1024
    s_nop 0
    s_add_u32 s67, s65, s63
    s_waitcnt lgkmcnt(0)
    v_add_u32 v0, v0, v4
    v_add_u32 v1, v1, v5
    v_add_u32 v2, v2, v6
    v_add_u32 v3, v3, v7
    v_and_b32 v4, 1, v0
    v_lshrrev_b32 v12, 1, v0
    v_lshlrev_b32 v12, 2, v12
    v_mad_u32_u24 v4, v4, s62, v12
    v_lshlrev_b32 v0, 3, v0
    v_and_b32 v5, 1, v1
    v_lshrrev_b32 v13, 1, v1
    v_lshlrev_b32 v13, 2, v13
    v_mad_u32_u24 v5, v5, s62, v13
    v_lshlrev_b32 v1, 3, v1
    v_and_b32 v6, 1, v2
    v_lshrrev_b32 v14, 1, v2
    v_lshlrev_b32 v14, 2, v14
    v_mad_u32_u24 v6, v6, s62, v14
    v_lshlrev_b32 v2, 3, v2
    v_and_b32 v7, 1, v3
    v_lshrrev_b32 v15, 1, v3
    v_lshlrev_b32 v15, 2, v15
    v_mad_u32_u24 v7, v7, s62, v15
    v_lshlrev_b32 v3, 3, v3
    s_mov_b64 exec, s[52:53]
    s_cbranch_execz k2_w0
    ds_write_b32 v4, v22 offset:40960
    ds_write_b64 v0, v[20:21] offset:53440
    s_mov_b64 exec, s[54:55]
    s_cbranch_execz k2_w0
    ds_write_b32 v5, v26 offset:40960
    ds_write_b64 v1, v[24:25] offset:53440
    s_mov_b64 exec, s[56:57]
    s_cbranch_execz k2_w0
    ds_write_b32 v6, v30 offset:40960
    ds_write_b64 v2, v[28:29] offset:53440
k2_w0:
    s_mov_b64 exec, s[6:7]
    s_cbranch_execz k2_nopad
    v_mov_b32 v13, 0xaa07fff
    v_mov_b64 v[14:15], 0
    ds_write_b32 v7, v13 offset:40960
    ds_write_b64 v3, v[14:15] offset:53440
k2_nopad:
    s_mov_b64 exec, -1
    buffer_load_dwordx4 v36, s[16:19], 0 offen sc1 lds
    s_add_u32 m0, m0, 1024
    s_nop 0
    s_mov_b64 exec, 0xfffff
    buffer_load_dwordx4 v37, s[16:19], 0 offen sc1 lds
    s_mov_b64 exec, -1
    s_nop 0
    s_lshl_b32 s3, s67, 4
    s_add_u32 s3, s3, 40960
    v_mov_b32 v12, s3
    v_mad_u32_u24 v123, v11, s62, v12
    v_lshrrev_b32 v13, 3, v10
    v_lshl_add_u32 v12, v13, 4, v12
    v_and_b32 v13, 3, v10
    v_lshl_add_u32 v12, v13, 2, v12
    v_bfe_u32 v13, v10, 2, 1
    v_mad_u32_u24 v125, v13, s62, v12
    s_lshl_b32 s3, s67, 6
    s_add_u32 s3, s3, 53440
    v_lshlrev_b32 v12, 3, v11
    v_lshl_add_u32 v12, v10, 4, v12
    v_add_u32 v124, s3, v12
    v_lshlrev_b32 v12, 4, v11
    v_add_u32 v105, 76096, v12
    v_lshlrev_b32 v126, 4, v122
    v_lshlrev_b32 v122, 4, v10
    v_mov_b64 v[80:81], 0
    v_mov_b64 v[82:83], 0
    v_mov_b64 v[84:85], 0
    v_mov_b64 v[86:87], 0
    v_and_or_b32 v40, v122, 48, s51
    s_mov_b32 s43, s39
    s_lshr_b32 s71, s39, 1
    s_mov_b32 s11, 3
    s_setprio 3
    s_waitcnt lgkmcnt(0)
    s_barrier
    ds_read_u16 v114, v123 offset:0
    ds_read_u16 v116, v123 offset:4
    ds_read_u16 v118, v123 offset:8
    ds_read_u16 v120, v123 offset:12
    ds_read_u16 v72, v123 offset:16
    ds_read_u16 v74, v123 offset:20
    ds_read_u16 v76, v123 offset:24
    ds_read_u16 v78, v123 offset:28
    v_mov_b32 v115, v122
    v_mov_b32 v73, v122
    v_mov_b32 v117, v122
    v_mov_b32 v75, v122
    v_mov_b32 v119, v122
    v_mov_b32 v77, v122
    v_mov_b32 v121, v122
    v_mov_b32 v79, v122
    ds_read_b32 v104, v125
    ds_read_b64 v[112:113], v124
    ds_read_b128 v[32:35], v40
    ds_read_b128 v[36:39], v40 offset:64
    s_cmp_gt_u32 s43, 0
    s_cselect_b32 s14, s42, 0
    s_waitcnt lgkmcnt(10)
    buffer_load_dwordx4 v[0:3], v[114:115], s[12:15], 0 idxen offen
    buffer_load_dwordx4 v[4:7], v[116:117], s[12:15], 0 idxen offen
    s_waitcnt lgkmcnt(4)
    v_bfe_u32 v48, v66, 1, 15
    v_lshrrev_b32 v49, 17, v66
    s_lshl_b32 s4, s63, 2
    s_lshl_b32 s3, s65, 2
    v_cmp_lt_u32 vcc, 0, v68
    v_cmp_lt_u32 s[68:69], 0, v69
    v_cmp_lt_u32 s[48:49], s4, v48
    v_cmp_lt_u32 s[88:89], s3, v49
    s_lshl_b32 s6, s64, 2
    s_lshl_b32 s7, s39, 2
    s_add_u32 s4, s4, 1
    s_sub_u32 s5, s3, s6
    s_add_u32 s5, s5, 1
    s_sub_u32 s6, s6, 1
    s_sub_u32 s7, s7, 1
    v_subrev_u32 v48, s4, v48
    v_subrev_u32 v49, s5, v49
    s_and_b64 s[48:49], s[48:49], vcc
    s_and_b64 s[88:89], s[88:89], s[68:69]
    v_min_u32 v48, s6, v48
    v_min_u32 v49, s7, v49
    s_cmp_lg_u32 s64, 0
    s_cselect_b64 s[58:59], s[48:49], 0
    s_cmp_lg_u32 s66, 0
    s_cselect_b64 s[68:69], s[88:89], 0
    v_cmp_gt_u32 s[4:5], s6, v48
    v_cmp_gt_u32 vcc, 64, v48
    v_cmp_gt_u32 s[62:63], 64, v49
    v_cndmask_b32 v50, 0, 1, s[58:59]
    v_mov_b32 v51, 0
    v_cndmask_b32 v52, 0, 1, s[68:69]
    v_mov_b32 v53, 0
    v_lshlrev_b64 v[50:51], v48, v[50:51]
    v_lshlrev_b64 v[52:53], v49, v[52:53]
    s_and_b64 s[4:5], s[4:5], s[58:59]
    s_bcnt1_i32_b64 s90, s[4:5]
    s_andn2_b64 s[4:5], s[58:59], s[4:5]
    s_addc_u32 s90, s90, 0
    v_cndmask_b32 v54, v50, 0, vcc
    v_cndmask_b32 v55, v52, 0, s[62:63]
    v_cndmask_b32 v50, 0, v50, vcc
    v_cndmask_b32 v52, 0, v52, s[62:63]
    v_or_b32 v51, v51, v53
    v_or_b32 v54, v54, v55
    v_or_b32 v50, v50, v52
    s_mov_b32 s70, 0
    v_or_b32_dpp v51, v51, v51 row_shr:1 row_mask:0xf bank_mask:0xf bound_ctrl:1
    v_or_b32_dpp v54, v54, v54 row_shr:1 row_mask:0xf bank_mask:0xf bound_ctrl:1
    v_or_b32_dpp v50, v50, v50 row_shr:1 row_mask:0xf bank_mask:0xf bound_ctrl:1
    v_or_b32_dpp v51, v51, v51 row_shr:2 row_mask:0xf bank_mask:0xf bound_ctrl:1
    v_or_b32_dpp v54, v54, v54 row_shr:2 row_mask:0xf bank_mask:0xf bound_ctrl:1
    v_or_b32_dpp v50, v50, v50 row_shr:2 row_mask:0xf bank_mask:0xf bound_ctrl:1
    v_or_b32_dpp v51, v51, v51 row_shr:4 row_mask:0xf bank_mask:0xf bound_ctrl:1
    v_or_b32_dpp v54, v54, v54 row_shr:4 row_mask:0xf bank_mask:0xf bound_ctrl:1
    v_or_b32_dpp v50, v50, v50 row_shr:4 row_mask:0xf bank_mask:0xf bound_ctrl:1
    v_or_b32_dpp v51, v51, v51 row_shr:8 row_mask:0xf bank_mask:0xf bound_ctrl:1
    v_or_b32_dpp v54, v54, v54 row_shr:8 row_mask:0xf bank_mask:0xf bound_ctrl:1
    v_or_b32_dpp v50, v50, v50 row_shr:8 row_mask:0xf bank_mask:0xf bound_ctrl:1
    v_or_b32_dpp v51, v51, v51 row_bcast:15 row_mask:0xa bank_mask:0xf
    v_or_b32_dpp v54, v54, v54 row_bcast:15 row_mask:0xa bank_mask:0xf
    v_or_b32_dpp v50, v50, v50 row_bcast:15 row_mask:0xa bank_mask:0xf
    v_or_b32_dpp v51, v51, v51 row_bcast:31 row_mask:0xc bank_mask:0xf
    v_or_b32_dpp v54, v54, v54 row_bcast:31 row_mask:0xc bank_mask:0xf
    v_or_b32_dpp v50, v50, v50 row_bcast:31 row_mask:0xc bank_mask:0xf
    v_readlane_b32 s45, v51, 63
    v_readlane_b32 s46, v54, 63
    v_readlane_b32 s44, v50, 63
    s_waitcnt vmcnt(2)
    s_barrier
    s_cmp_eq_u32 s39, 0
    s_cbranch_scc1 k2_done
    s_waitcnt lgkmcnt(0)
    v_mad_u32_u16 v88, v104, 32, v105 op_sel:[1,0,0,0]
    ds_read_b128 v[108:111], v88
    ds_read_b32 v104, v125 offset:64
    buffer_load_dwordx4 v[8:11], v[118:119], s[12:15], 0 idxen offen
    buffer_load_dwordx4 v[12:15], v[120:121], s[12:15], 0 idxen offen
    s_cmp_gt_u32 s43, 1
    s_cselect_b32 s14, s42, 0
    buffer_load_dwordx4 v[16:19], v[72:73], s[12:15], 0 idxen offen
    buffer_load_dwordx4 v[20:23], v[74:75], s[12:15], 0 idxen offen
    buffer_load_dwordx4 v[24:27], v[76:77], s[12:15], 0 idxen offen
    buffer_load_dwordx4 v[28:31], v[78:79], s[12:15], 0 idxen offen
    ds_read_u16 v114, v123 offset:32
    ds_read_u16 v116, v123 offset:36
    ds_read_u16 v118, v123 offset:40
    ds_read_u16 v120, v123 offset:44
k2_blk:
    s_waitcnt lgkmcnt(3)
    v_mfma_f32_4x4x4_16b_bf16 v[48:51], v[112:113], v[32:33], 0
    v_mfma_f32_4x4x4_16b_bf16 v[52:55], v[112:113], v[34:35], 0
    v_mfma_f32_4x4x4_16b_bf16 v[56:59], v[112:113], v[36:37], 0
    v_mfma_f32_4x4x4_16b_bf16 v[60:63], v[112:113], v[38:39], 0
    ds_read_b64 v[112:113], v124 offset:512
    v_add_u32 v124, 512, v124
    v_mfma_f32_32x32x16_bf16 v[32:47], v[108:111], v[92:95], 0
    v_cvt_pk_bf16_f32 v64, v48, v52
    v_cvt_pk_bf16_f32 v66, v49, v53
    v_cvt_pk_bf16_f32 v68, v50, v54
    v_cvt_pk_bf16_f32 v70, v51, v55
    v_cvt_pk_bf16_f32 v65, v56, v60
    v_cvt_pk_bf16_f32 v67, v57, v61
    v_cvt_pk_bf16_f32 v69, v58, v62
    v_cvt_pk_bf16_f32 v71, v59, v63
    v_mfma_f32_32x32x16_bf16 v[48:63], v[108:111], v[96:99], 0
    v_mad_u32_u16 v88, v104, 32, v105 op_sel:[1,0,0,0]
    ds_read_b128 v[108:111], v88
    ds_read_b32 v104, v125 offset:128
    s_cmp_gt_u32 s43, 2
    s_cselect_b32 s14, s42, 0
    s_nop 7
    v_exp_f32 v88, v32
    v_exp_f32 v89, v33
    v_exp_f32 v90, v48
    v_exp_f32 v91, v49
    v_pk_add_f32 v[88:89], v[88:89], s[40:41]
    v_pk_add_f32 v[90:91], v[90:91], s[40:41]
    v_rcp_f32 v88, v88
    v_rcp_f32 v89, v89
    v_rcp_f32 v90, v90
    v_rcp_f32 v91, v91
    v_pk_mul_f32 v[32:33], v[32:33], v[88:89]
    v_pk_mul_f32 v[48:49], v[48:49], v[90:91]
    s_waitcnt vmcnt(7) lgkmcnt(3)
    v_mfma_f32_4x4x4_16b_bf16 v[72:75], v[64:65], v[0:1], 0 cbsz:3 abid:0
    v_exp_f32 v88, v34
    v_exp_f32 v89, v35
    v_mfma_f32_4x4x4_16b_bf16 v[76:79], v[64:65], v[2:3], 0 cbsz:3 abid:0
    buffer_load_dwordx4 v[0:3], v[114:115], s[12:15], 0 idxen offen
    ds_read_u16 v114, v123 offset:48
    v_exp_f32 v90, v50
    v_exp_f32 v91, v51
    v_pk_add_f32 v[88:89], v[88:89], s[40:41]
    v_pk_fma_f32 v[80:81], v[32:33], v[72:73], v[80:81] op_sel_hi:[0,1,1]
    v_pk_fma_f32 v[82:83], v[32:33], v[74:75], v[82:83] op_sel_hi:[0,1,1]
    v_pk_add_f32 v[90:91], v[90:91], s[40:41]
    v_pk_fma_f32 v[84:85], v[48:49], v[76:77], v[84:85] op_sel_hi:[0,1,1]
    v_pk_fma_f32 v[86:87], v[48:49], v[78:79], v[86:87] op_sel_hi:[0,1,1]
    s_bitcmp1_b32 s44, 0
    s_cbranch_scc1 k2_fl0
k2_bk0:
    s_waitcnt vmcnt(7) lgkmcnt(3)
    v_mfma_f32_4x4x4_16b_bf16 v[72:75], v[66:67], v[4:5], 0 cbsz:3 abid:0
    v_rcp_f32 v88, v88
    v_rcp_f32 v89, v89
    v_mfma_f32_4x4x4_16b_bf16 v[76:79], v[66:67], v[6:7], 0 cbsz:3 abid:0
    buffer_load_dwordx4 v[4:7], v[116:117], s[12:15], 0 idxen offen
    ds_read_u16 v116, v123 offset:52
    v_rcp_f32 v90, v90
    v_rcp_f32 v91, v91
    v_pk_mul_f32 v[34:35], v[34:35], v[88:89]
    v_pk_fma_f32 v[80:81], v[32:33], v[72:73], v[80:81] op_sel:[1,0,0] op_sel_hi:[1,1,1]
    v_pk_fma_f32 v[82:83], v[32:33], v[74:75], v[82:83] op_sel:[1,0,0] op_sel_hi:[1,1,1]
    v_pk_mul_f32 v[50:51], v[50:51], v[90:91]
    v_pk_fma_f32 v[84:85], v[48:49], v[76:77], v[84:85] op_sel:[1,0,0] op_sel_hi:[1,1,1]
    v_pk_fma_f32 v[86:87], v[48:49], v[78:79], v[86:87] op_sel:[1,0,0] op_sel_hi:[1,1,1]
    s_bitcmp1_b32 s44, 1
    s_cbranch_scc1 k2_fl1
k2_bk1:
    s_waitcnt vmcnt(7) lgkmcnt(3)
    v_mfma_f32_4x4x4_16b_bf16 v[72:75], v[68:69], v[8:9], 0 cbsz:3 abid:0
    v_exp_f32 v88, v36
    v_exp_f32 v89, v37
    v_mfma_f32_4x4x4_16b_bf16 v[76:79], v[68:69], v[10:11], 0 cbsz:3 abid:0
    buffer_load_dwordx4 v[8:11], v[118:119], s[12:15], 0 idxen offen
    ds_read_u16 v118, v123 offset:56
    v_exp_f32 v90, v52
    v_exp_f32 v91, v53
    v_pk_add_f32 v[88:89], v[88:89], s[40:41]
    v_pk_fma_f32 v[80:81], v[34:35], v[72:73], v[80:81] op_sel_hi:[0,1,1]
    v_pk_fma_f32 v[82:83], v[34:35], v[74:75], v[82:83] op_sel_hi:[0,1,1]
    v_pk_add_f32 v[90:91], v[90:91], s[40:41]
    v_pk_fma_f32 v[84:85], v[50:51], v[76:77], v[84:85] op_sel_hi:[0,1,1]
    v_pk_fma_f32 v[86:87], v[50:51], v[78:79], v[86:87] op_sel_hi:[0,1,1]
    s_bitcmp1_b32 s44, 2
    s_cbranch_scc1 k2_fl2
k2_bk2:
    s_waitcnt vmcnt(7) lgkmcnt(3)
    v_mfma_f32_4x4x4_16b_bf16 v[72:75], v[70:71], v[12:13], 0 cbsz:3 abid:0
    v_rcp_f32 v88, v88
    v_rcp_f32 v89, v89
    v_mfma_f32_4x4x4_16b_bf16 v[76:79], v[70:71], v[14:15], 0 cbsz:3 abid:0
    buffer_load_dwordx4 v[12:15], v[120:121], s[12:15], 0 idxen offen
    ds_read_u16 v120, v123 offset:60
    v_rcp_f32 v90, v90
    v_rcp_f32 v91, v91
    v_pk_mul_f32 v[36:37], v[36:37], v[88:89]
    v_pk_fma_f32 v[80:81], v[34:35], v[72:73], v[80:81] op_sel:[1,0,0] op_sel_hi:[1,1,1]
    v_pk_fma_f32 v[82:83], v[34:35], v[74:75], v[82:83] op_sel:[1,0,0] op_sel_hi:[1,1,1]
    v_pk_mul_f32 v[52:53], v[52:53], v[90:91]
    v_pk_fma_f32 v[84:85], v[50:51], v[76:77], v[84:85] op_sel:[1,0,0] op_sel_hi:[1,1,1]
    v_pk_fma_f32 v[86:87], v[50:51], v[78:79], v[86:87] op_sel:[1,0,0] op_sel_hi:[1,1,1]
    s_bitcmp1_b32 s44, 3
    s_cbranch_scc1 k2_fl3
k2_bk3:
    s_sub_u32 s43, s43, 1
    s_cmp_eq_u32 s43, s71
    s_cbranch_scc1 k2_th0
k2_tb0:
    s_cmp_gt_u32 s43, 2
    s_cselect_b32 s14, s42, 0
    s_waitcnt vmcnt(7) lgkmcnt(3)
    v_mfma_f32_4x4x4_16b_bf16 v[72:75], v[64:65], v[16:17], 0 cbsz:3 abid:1
    v_exp_f32 v88, v38
    v_exp_f32 v89, v39
    v_mfma_f32_4x4x4_16b_bf16 v[76:79], v[64:65], v[18:19], 0 cbsz:3 abid:1
    buffer_load_dwordx4 v[16:19], v[114:115], s[12:15], 0 idxen offen
    ds_read_u16 v114, v123 offset:64
    v_exp_f32 v90, v54
    v_exp_f32 v91, v55
    v_pk_add_f32 v[88:89], v[88:89], s[40:41]
    v_pk_fma_f32 v[80:81], v[36:37], v[72:73], v[80:81] op_sel_hi:[0,1,1]
    v_pk_fma_f32 v[82:83], v[36:37], v[74:75], v[82:83] op_sel_hi:[0,1,1]
    v_pk_add_f32 v[90:91], v[90:91], s[40:41]
    v_pk_fma_f32 v[84:85], v[52:53], v[76:77], v[84:85] op_sel_hi:[0,1,1]
    v_pk_fma_f32 v[86:87], v[52:53], v[78:79], v[86:87] op_sel_hi:[0,1,1]
    s_bitcmp1_b32 s44, 4
    s_cbranch_scc1 k2_fl4
k2_bk4:
    s_waitcnt vmcnt(7) lgkmcnt(3)
    v_mfma_f32_4x4x4_16b_bf16 v[72:75], v[66:67], v[20:21], 0 cbsz:3 abid:1
    v_rcp_f32 v88, v88
    v_rcp_f32 v89, v89
    v_mfma_f32_4x4x4_16b_bf16 v[76:79], v[66:67], v[22:23], 0 cbsz:3 abid:1
    buffer_load_dwordx4 v[20:23], v[116:117], s[12:15], 0 idxen offen
    ds_read_u16 v116, v123 offset:68
    v_rcp_f32 v90, v90
    v_rcp_f32 v91, v91
    v_pk_mul_f32 v[38:39], v[38:39], v[88:89]
    v_pk_fma_f32 v[80:81], v[36:37], v[72:73], v[80:81] op_sel:[1,0,0] op_sel_hi:[1,1,1]
    v_pk_fma_f32 v[82:83], v[36:37], v[74:75], v[82:83] op_sel:[1,0,0] op_sel_hi:[1,1,1]
    v_pk_mul_f32 v[54:55], v[54:55], v[90:91]
    v_pk_fma_f32 v[84:85], v[52:53], v[76:77], v[84:85] op_sel:[1,0,0] op_sel_hi:[1,1,1]
    v_pk_fma_f32 v[86:87], v[52:53], v[78:79], v[86:87] op_sel:[1,0,0] op_sel_hi:[1,1,1]
    s_bitcmp1_b32 s44, 5
    s_cbranch_scc1 k2_fl5
k2_bk5:
    s_waitcnt vmcnt(7) lgkmcnt(3)
    v_mfma_f32_4x4x4_16b_bf16 v[72:75], v[68:69], v[24:25], 0 cbsz:3 abid:1
    v_exp_f32 v88, v40
    v_exp_f32 v89, v41
    v_mfma_f32_4x4x4_16b_bf16 v[76:79], v[68:69], v[26:27], 0 cbsz:3 abid:1
    buffer_load_dwordx4 v[24:27], v[118:119], s[12:15], 0 idxen offen
    ds_read_u16 v118, v123 offset:72
    v_exp_f32 v90, v56
    v_exp_f32 v91, v57
    v_pk_add_f32 v[88:89], v[88:89], s[40:41]
    v_pk_fma_f32 v[80:81], v[38:39], v[72:73], v[80:81] op_sel_hi:[0,1,1]
    v_pk_fma_f32 v[82:83], v[38:39], v[74:75], v[82:83] op_sel_hi:[0,1,1]
    v_pk_add_f32 v[90:91], v[90:91], s[40:41]
    v_pk_fma_f32 v[84:85], v[54:55], v[76:77], v[84:85] op_sel_hi:[0,1,1]
    v_pk_fma_f32 v[86:87], v[54:55], v[78:79], v[86:87] op_sel_hi:[0,1,1]
    s_bitcmp1_b32 s44, 6
    s_cbranch_scc1 k2_fl6
k2_bk6:
    s_waitcnt vmcnt(7) lgkmcnt(3)
    v_mfma_f32_4x4x4_16b_bf16 v[72:75], v[70:71], v[28:29], 0 cbsz:3 abid:1
    v_rcp_f32 v88, v88
    v_rcp_f32 v89, v89
    v_mfma_f32_4x4x4_16b_bf16 v[76:79], v[70:71], v[30:31], 0 cbsz:3 abid:1
    buffer_load_dwordx4 v[28:31], v[120:121], s[12:15], 0 idxen offen
    ds_read_u16 v120, v123 offset:76
    v_rcp_f32 v90, v90
    v_rcp_f32 v91, v91
    v_pk_mul_f32 v[40:41], v[40:41], v[88:89]
    v_pk_fma_f32 v[80:81], v[38:39], v[72:73], v[80:81] op_sel:[1,0,0] op_sel_hi:[1,1,1]
    v_pk_fma_f32 v[82:83], v[38:39], v[74:75], v[82:83] op_sel:[1,0,0] op_sel_hi:[1,1,1]
    v_pk_mul_f32 v[56:57], v[56:57], v[90:91]
    v_pk_fma_f32 v[84:85], v[54:55], v[76:77], v[84:85] op_sel:[1,0,0] op_sel_hi:[1,1,1]
    v_pk_fma_f32 v[86:87], v[54:55], v[78:79], v[86:87] op_sel:[1,0,0] op_sel_hi:[1,1,1]
    s_bitcmp1_b32 s44, 7
    s_cbranch_scc1 k2_fl7
k2_bk7:
    s_sub_u32 s43, s43, 1
    s_cmp_eq_u32 s43, s71
    s_cbranch_scc1 k2_th1
k2_tb1:
    s_cmp_gt_u32 s43, 2
    s_cselect_b32 s14, s42, 0
    s_waitcnt vmcnt(7) lgkmcnt(3)
    v_mfma_f32_4x4x4_16b_bf16 v[72:75], v[64:65], v[0:1], 0 cbsz:3 abid:2
    v_exp_f32 v88, v42
    v_exp_f32 v89, v43
    v_mfma_f32_4x4x4_16b_bf16 v[76:79], v[64:65], v[2:3], 0 cbsz:3 abid:2
    buffer_load_dwordx4 v[0:3], v[114:115], s[12:15], 0 idxen offen
    ds_read_u16 v114, v123 offset:80
    v_exp_f32 v90, v58
    v_exp_f32 v91, v59
    v_pk_add_f32 v[88:89], v[88:89], s[40:41]
    v_pk_fma_f32 v[80:81], v[40:41], v[72:73], v[80:81] op_sel_hi:[0,1,1]
    v_pk_fma_f32 v[82:83], v[40:41], v[74:75], v[82:83] op_sel_hi:[0,1,1]
    v_pk_add_f32 v[90:91], v[90:91], s[40:41]
    v_pk_fma_f32 v[84:85], v[56:57], v[76:77], v[84:85] op_sel_hi:[0,1,1]
    v_pk_fma_f32 v[86:87], v[56:57], v[78:79], v[86:87] op_sel_hi:[0,1,1]
    s_bitcmp1_b32 s44, 8
    s_cbranch_scc1 k2_fl8
k2_bk8:
    s_waitcnt vmcnt(7) lgkmcnt(3)
    v_mfma_f32_4x4x4_16b_bf16 v[72:75], v[66:67], v[4:5], 0 cbsz:3 abid:2
    v_rcp_f32 v88, v88
    v_rcp_f32 v89, v89
    v_mfma_f32_4x4x4_16b_bf16 v[76:79], v[66:67], v[6:7], 0 cbsz:3 abid:2
    buffer_load_dwordx4 v[4:7], v[116:117], s[12:15], 0 idxen offen
    ds_read_u16 v116, v123 offset:84
    v_rcp_f32 v90, v90
    v_rcp_f32 v91, v91
    v_pk_mul_f32 v[42:43], v[42:43], v[88:89]
    v_pk_fma_f32 v[80:81], v[40:41], v[72:73], v[80:81] op_sel:[1,0,0] op_sel_hi:[1,1,1]
    v_pk_fma_f32 v[82:83], v[40:41], v[74:75], v[82:83] op_sel:[1,0,0] op_sel_hi:[1,1,1]
    v_pk_mul_f32 v[58:59], v[58:59], v[90:91]
    v_pk_fma_f32 v[84:85], v[56:57], v[76:77], v[84:85] op_sel:[1,0,0] op_sel_hi:[1,1,1]
    v_pk_fma_f32 v[86:87], v[56:57], v[78:79], v[86:87] op_sel:[1,0,0] op_sel_hi:[1,1,1]
    s_bitcmp1_b32 s44, 9
    s_cbranch_scc1 k2_fl9
k2_bk9:
    s_waitcnt vmcnt(7) lgkmcnt(3)
    v_mfma_f32_4x4x4_16b_bf16 v[72:75], v[68:69], v[8:9], 0 cbsz:3 abid:2
    v_exp_f32 v88, v44
    v_exp_f32 v89, v45
    v_mfma_f32_4x4x4_16b_bf16 v[76:79], v[68:69], v[10:11], 0 cbsz:3 abid:2
    buffer_load_dwordx4 v[8:11], v[118:119], s[12:15], 0 idxen offen
    ds_read_u16 v118, v123 offset:88
    v_exp_f32 v90, v60
    v_exp_f32 v91, v61
    v_pk_add_f32 v[88:89], v[88:89], s[40:41]
    v_pk_fma_f32 v[80:81], v[42:43], v[72:73], v[80:81] op_sel_hi:[0,1,1]
    v_pk_fma_f32 v[82:83], v[42:43], v[74:75], v[82:83] op_sel_hi:[0,1,1]
    v_pk_add_f32 v[90:91], v[90:91], s[40:41]
    v_pk_fma_f32 v[84:85], v[58:59], v[76:77], v[84:85] op_sel_hi:[0,1,1]
    v_pk_fma_f32 v[86:87], v[58:59], v[78:79], v[86:87] op_sel_hi:[0,1,1]
    s_bitcmp1_b32 s44, 10
    s_cbranch_scc1 k2_fl10
k2_bk10:
    s_waitcnt vmcnt(7) lgkmcnt(3)
    v_mfma_f32_4x4x4_16b_bf16 v[72:75], v[70:71], v[12:13], 0 cbsz:3 abid:2
    v_rcp_f32 v88, v88
    v_rcp_f32 v89, v89
    v_mfma_f32_4x4x4_16b_bf16 v[76:79], v[70:71], v[14:15], 0 cbsz:3 abid:2
    buffer_load_dwordx4 v[12:15], v[120:121], s[12:15], 0 idxen offen
    ds_read_u16 v120, v123 offset:92
    v_rcp_f32 v90, v90
    v_rcp_f32 v91, v91
    v_pk_mul_f32 v[44:45], v[44:45], v[88:89]
    v_pk_fma_f32 v[80:81], v[42:43], v[72:73], v[80:81] op_sel:[1,0,0] op_sel_hi:[1,1,1]
    v_pk_fma_f32 v[82:83], v[42:43], v[74:75], v[82:83] op_sel:[1,0,0] op_sel_hi:[1,1,1]
    v_pk_mul_f32 v[60:61], v[60:61], v[90:91]
    v_pk_fma_f32 v[84:85], v[58:59], v[76:77], v[84:85] op_sel:[1,0,0] op_sel_hi:[1,1,1]
    v_pk_fma_f32 v[86:87], v[58:59], v[78:79], v[86:87] op_sel:[1,0,0] op_sel_hi:[1,1,1]
    s_bitcmp1_b32 s44, 11
    s_cbranch_scc1 k2_fl11
k2_bk11:
    s_sub_u32 s43, s43, 1
    s_cmp_eq_u32 s43, s71
    s_cbranch_scc1 k2_th2
k2_tb2:
    s_cmp_gt_u32 s43, 2
    s_cselect_b32 s14, s42, 0
    s_waitcnt vmcnt(7) lgkmcnt(3)
    v_mfma_f32_4x4x4_16b_bf16 v[72:75], v[64:65], v[16:17], 0 cbsz:3 abid:3
    v_exp_f32 v88, v46
    v_exp_f32 v89, v47
    v_mfma_f32_4x4x4_16b_bf16 v[76:79], v[64:65], v[18:19], 0 cbsz:3 abid:3
    buffer_load_dwordx4 v[16:19], v[114:115], s[12:15], 0 idxen offen
    ds_read_u16 v114, v123 offset:96
    v_exp_f32 v90, v62
    v_exp_f32 v91, v63
    v_pk_add_f32 v[88:89], v[88:89], s[40:41]
    v_pk_fma_f32 v[80:81], v[44:45], v[72:73], v[80:81] op_sel_hi:[0,1,1]
    v_pk_fma_f32 v[82:83], v[44:45], v[74:75], v[82:83] op_sel_hi:[0,1,1]
    v_pk_add_f32 v[90:91], v[90:91], s[40:41]
    v_pk_fma_f32 v[84:85], v[60:61], v[76:77], v[84:85] op_sel_hi:[0,1,1]
    v_pk_fma_f32 v[86:87], v[60:61], v[78:79], v[86:87] op_sel_hi:[0,1,1]
    s_bitcmp1_b32 s44, 12
    s_cbranch_scc1 k2_fl12
k2_bk12:
    s_waitcnt vmcnt(7) lgkmcnt(3)
    v_mfma_f32_4x4x4_16b_bf16 v[72:75], v[66:67], v[20:21], 0 cbsz:3 abid:3
    v_rcp_f32 v88, v88
    v_rcp_f32 v89, v89
    v_mfma_f32_4x4x4_16b_bf16 v[76:79], v[66:67], v[22:23], 0 cbsz:3 abid:3
    buffer_load_dwordx4 v[20:23], v[116:117], s[12:15], 0 idxen offen
    ds_read_u16 v116, v123 offset:100
    v_rcp_f32 v90, v90
    v_rcp_f32 v91, v91
    v_pk_mul_f32 v[46:47], v[46:47], v[88:89]
    v_pk_fma_f32 v[80:81], v[44:45], v[72:73], v[80:81] op_sel:[1,0,0] op_sel_hi:[1,1,1]
    v_pk_fma_f32 v[82:83], v[44:45], v[74:75], v[82:83] op_sel:[1,0,0] op_sel_hi:[1,1,1]
    v_pk_mul_f32 v[62:63], v[62:63], v[90:91]
    v_pk_fma_f32 v[84:85], v[60:61], v[76:77], v[84:85] op_sel:[1,0,0] op_sel_hi:[1,1,1]
    v_pk_fma_f32 v[86:87], v[60:61], v[78:79], v[86:87] op_sel:[1,0,0] op_sel_hi:[1,1,1]
    s_bitcmp1_b32 s44, 13
    s_cbranch_scc1 k2_fl13
k2_bk13:
    s_waitcnt vmcnt(7) lgkmcnt(3)
    v_mfma_f32_4x4x4_16b_bf16 v[72:75], v[68:69], v[24:25], 0 cbsz:3 abid:3
    v_mfma_f32_4x4x4_16b_bf16 v[76:79], v[68:69], v[26:27], 0 cbsz:3 abid:3
    buffer_load_dwordx4 v[24:27], v[118:119], s[12:15], 0 idxen offen
    ds_read_u16 v118, v123 offset:104
    s_nop 2
    v_pk_fma_f32 v[80:81], v[46:47], v[72:73], v[80:81] op_sel_hi:[0,1,1]
    v_pk_fma_f32 v[82:83], v[46:47], v[74:75], v[82:83] op_sel_hi:[0,1,1]
    v_pk_fma_f32 v[84:85], v[62:63], v[76:77], v[84:85] op_sel_hi:[0,1,1]
    v_pk_fma_f32 v[86:87], v[62:63], v[78:79], v[86:87] op_sel_hi:[0,1,1]
    s_bitcmp1_b32 s44, 14
    s_cbranch_scc1 k2_fl14
k2_bk14:
    s_waitcnt vmcnt(7) lgkmcnt(3)
    v_mfma_f32_4x4x4_16b_bf16 v[72:75], v[70:71], v[28:29], 0 cbsz:3 abid:3
    v_mfma_f32_4x4x4_16b_bf16 v[76:79], v[70:71], v[30:31], 0 cbsz:3 abid:3
    buffer_load_dwordx4 v[28:31], v[120:121], s[12:15], 0 idxen offen
    ds_read_u16 v120, v123 offset:108
    s_nop 2
    v_pk_fma_f32 v[80:81], v[46:47], v[72:73], v[80:81] op_sel:[1,0,0] op_sel_hi:[1,1,1]
    v_pk_fma_f32 v[82:83], v[46:47], v[74:75], v[82:83] op_sel:[1,0,0] op_sel_hi:[1,1,1]
    v_pk_fma_f32 v[84:85], v[62:63], v[76:77], v[84:85] op_sel:[1,0,0] op_sel_hi:[1,1,1]
    v_pk_fma_f32 v[86:87], v[62:63], v[78:79], v[86:87] op_sel:[1,0,0] op_sel_hi:[1,1,1]
    s_bitcmp1_b32 s44, 15
    s_cbranch_scc1 k2_fl15
k2_bk15:
    s_sub_u32 s43, s43, 1
    s_cmp_eq_u32 s43, s71
    s_cbranch_scc1 k2_th3
k2_tb3:
    s_waitcnt lgkmcnt(3)
    v_mfma_f32_32x32x16_bf16 v[32:47], v[108:111], v[92:95], 0
    v_mfma_f32_32x32x16_bf16 v[48:63], v[108:111], v[96:99], 0
    v_mad_u32_u16 v88, v104, 32, v105 op_sel:[1,0,0,0]
    ds_read_b128 v[108:111], v88
    ds_read_b32 v104, v125 offset:192
    v_add_u32 v125, 128, v125
    s_cmp_gt_u32 s43, 2
    s_cselect_b32 s14, s42, 0
    s_nop 7
    v_exp_f32 v88, v32
    v_exp_f32 v89, v33
    v_exp_f32 v90, v48
    v_exp_f32 v91, v49
    v_pk_add_f32 v[88:89], v[88:89], s[40:41]
    v_pk_add_f32 v[90:91], v[90:91], s[40:41]
    v_rcp_f32 v88, v88
    v_rcp_f32 v89, v89
    v_rcp_f32 v90, v90
    v_rcp_f32 v91, v91
    v_pk_mul_f32 v[32:33], v[32:33], v[88:89]
    v_pk_mul_f32 v[48:49], v[48:49], v[90:91]
    s_waitcnt vmcnt(7) lgkmcnt(3)
    v_mfma_f32_4x4x4_16b_bf16 v[72:75], v[64:65], v[0:1], 0 cbsz:3 abid:4
    v_exp_f32 v88, v34
    v_exp_f32 v89, v35
    v_mfma_f32_4x4x4_16b_bf16 v[76:79], v[64:65], v[2:3], 0 cbsz:3 abid:4
    buffer_load_dwordx4 v[0:3], v[114:115], s[12:15], 0 idxen offen
    ds_read_u16 v114, v123 offset:112
    v_exp_f32 v90, v50
    v_exp_f32 v91, v51
    v_pk_add_f32 v[88:89], v[88:89], s[40:41]
    v_pk_fma_f32 v[80:81], v[32:33], v[72:73], v[80:81] op_sel_hi:[0,1,1]
    v_pk_fma_f32 v[82:83], v[32:33], v[74:75], v[82:83] op_sel_hi:[0,1,1]
    v_pk_add_f32 v[90:91], v[90:91], s[40:41]
    v_pk_fma_f32 v[84:85], v[48:49], v[76:77], v[84:85] op_sel_hi:[0,1,1]
    v_pk_fma_f32 v[86:87], v[48:49], v[78:79], v[86:87] op_sel_hi:[0,1,1]
    s_bitcmp1_b32 s44, 16
    s_cbranch_scc1 k2_fl16
k2_bk16:
    s_waitcnt vmcnt(7) lgkmcnt(3)
    v_mfma_f32_4x4x4_16b_bf16 v[72:75], v[66:67], v[4:5], 0 cbsz:3 abid:4
    v_rcp_f32 v88, v88
    v_rcp_f32 v89, v89
    v_mfma_f32_4x4x4_16b_bf16 v[76:79], v[66:67], v[6:7], 0 cbsz:3 abid:4
    buffer_load_dwordx4 v[4:7], v[116:117], s[12:15], 0 idxen offen
    ds_read_u16 v116, v123 offset:116
    v_rcp_f32 v90, v90
    v_rcp_f32 v91, v91
    v_pk_mul_f32 v[34:35], v[34:35], v[88:89]
    v_pk_fma_f32 v[80:81], v[32:33], v[72:73], v[80:81] op_sel:[1,0,0] op_sel_hi:[1,1,1]
    v_pk_fma_f32 v[82:83], v[32:33], v[74:75], v[82:83] op_sel:[1,0,0] op_sel_hi:[1,1,1]
    v_pk_mul_f32 v[50:51], v[50:51], v[90:91]
    v_pk_fma_f32 v[84:85], v[48:49], v[76:77], v[84:85] op_sel:[1,0,0] op_sel_hi:[1,1,1]
    v_pk_fma_f32 v[86:87], v[48:49], v[78:79], v[86:87] op_sel:[1,0,0] op_sel_hi:[1,1,1]
    s_bitcmp1_b32 s44, 17
    s_cbranch_scc1 k2_fl17
k2_bk17:
    s_waitcnt vmcnt(7) lgkmcnt(3)
    v_mfma_f32_4x4x4_16b_bf16 v[72:75], v[68:69], v[8:9], 0 cbsz:3 abid:4
    v_exp_f32 v88, v36
    v_exp_f32 v89, v37
    v_mfma_f32_4x4x4_16b_bf16 v[76:79], v[68:69], v[10:11], 0 cbsz:3 abid:4
    buffer_load_dwordx4 v[8:11], v[118:119], s[12:15], 0 idxen offen
    ds_read_u16 v118, v123 offset:120
    v_exp_f32 v90, v52
    v_exp_f32 v91, v53
    v_pk_add_f32 v[88:89], v[88:89], s[40:41]
    v_pk_fma_f32 v[80:81], v[34:35], v[72:73], v[80:81] op_sel_hi:[0,1,1]
    v_pk_fma_f32 v[82:83], v[34:35], v[74:75], v[82:83] op_sel_hi:[0,1,1]
    v_pk_add_f32 v[90:91], v[90:91], s[40:41]
    v_pk_fma_f32 v[84:85], v[50:51], v[76:77], v[84:85] op_sel_hi:[0,1,1]
    v_pk_fma_f32 v[86:87], v[50:51], v[78:79], v[86:87] op_sel_hi:[0,1,1]
    s_bitcmp1_b32 s44, 18
    s_cbranch_scc1 k2_fl18
k2_bk18:
    s_waitcnt vmcnt(7) lgkmcnt(3)
    v_mfma_f32_4x4x4_16b_bf16 v[72:75], v[70:71], v[12:13], 0 cbsz:3 abid:4
    v_rcp_f32 v88, v88
    v_rcp_f32 v89, v89
    v_mfma_f32_4x4x4_16b_bf16 v[76:79], v[70:71], v[14:15], 0 cbsz:3 abid:4
    buffer_load_dwordx4 v[12:15], v[120:121], s[12:15], 0 idxen offen
    ds_read_u16 v120, v123 offset:124
    v_rcp_f32 v90, v90
    v_rcp_f32 v91, v91
    v_pk_mul_f32 v[36:37], v[36:37], v[88:89]
    v_pk_fma_f32 v[80:81], v[34:35], v[72:73], v[80:81] op_sel:[1,0,0] op_sel_hi:[1,1,1]
    v_pk_fma_f32 v[82:83], v[34:35], v[74:75], v[82:83] op_sel:[1,0,0] op_sel_hi:[1,1,1]
    v_pk_mul_f32 v[52:53], v[52:53], v[90:91]
    v_pk_fma_f32 v[84:85], v[50:51], v[76:77], v[84:85] op_sel:[1,0,0] op_sel_hi:[1,1,1]
    v_pk_fma_f32 v[86:87], v[50:51], v[78:79], v[86:87] op_sel:[1,0,0] op_sel_hi:[1,1,1]
    s_bitcmp1_b32 s44, 19
    s_cbranch_scc1 k2_fl19
k2_bk19:
    s_sub_u32 s43, s43, 1
    s_cmp_eq_u32 s43, s71
    s_cbranch_scc1 k2_th4
k2_tb4:
    s_cmp_gt_u32 s43, 2
    s_cselect_b32 s14, s42, 0
    s_waitcnt vmcnt(7) lgkmcnt(3)
    v_mfma_f32_4x4x4_16b_bf16 v[72:75], v[64:65], v[16:17], 0 cbsz:3 abid:5
    v_exp_f32 v88, v38
    v_exp_f32 v89, v39
    v_mfma_f32_4x4x4_16b_bf16 v[76:79], v[64:65], v[18:19], 0 cbsz:3 abid:5
    buffer_load_dwordx4 v[16:19], v[114:115], s[12:15], 0 idxen offen
    ds_read_u16 v114, v123 offset:128
    v_exp_f32 v90, v54
    v_exp_f32 v91, v55
    v_pk_add_f32 v[88:89], v[88:89], s[40:41]
    v_pk_fma_f32 v[80:81], v[36:37], v[72:73], v[80:81] op_sel_hi:[0,1,1]
    v_pk_fma_f32 v[82:83], v[36:37], v[74:75], v[82:83] op_sel_hi:[0,1,1]
    v_pk_add_f32 v[90:91], v[90:91], s[40:41]
    v_pk_fma_f32 v[84:85], v[52:53], v[76:77], v[84:85] op_sel_hi:[0,1,1]
    v_pk_fma_f32 v[86:87], v[52:53], v[78:79], v[86:87] op_sel_hi:[0,1,1]
    s_bitcmp1_b32 s44, 20
    s_cbranch_scc1 k2_fl20
k2_bk20:
    s_waitcnt vmcnt(7) lgkmcnt(3)
    v_mfma_f32_4x4x4_16b_bf16 v[72:75], v[66:67], v[20:21], 0 cbsz:3 abid:5
    v_rcp_f32 v88, v88
    v_rcp_f32 v89, v89
    v_mfma_f32_4x4x4_16b_bf16 v[76:79], v[66:67], v[22:23], 0 cbsz:3 abid:5
    buffer_load_dwordx4 v[20:23], v[116:117], s[12:15], 0 idxen offen
    ds_read_u16 v116, v123 offset:132
    v_rcp_f32 v90, v90
    v_rcp_f32 v91, v91
    v_pk_mul_f32 v[38:39], v[38:39], v[88:89]
    v_pk_fma_f32 v[80:81], v[36:37], v[72:73], v[80:81] op_sel:[1,0,0] op_sel_hi:[1,1,1]
    v_pk_fma_f32 v[82:83], v[36:37], v[74:75], v[82:83] op_sel:[1,0,0] op_sel_hi:[1,1,1]
    v_pk_mul_f32 v[54:55], v[54:55], v[90:91]
    v_pk_fma_f32 v[84:85], v[52:53], v[76:77], v[84:85] op_sel:[1,0,0] op_sel_hi:[1,1,1]
    v_pk_fma_f32 v[86:87], v[52:53], v[78:79], v[86:87] op_sel:[1,0,0] op_sel_hi:[1,1,1]
    s_bitcmp1_b32 s44, 21
    s_cbranch_scc1 k2_fl21
k2_bk21:
    s_waitcnt vmcnt(7) lgkmcnt(3)
    v_mfma_f32_4x4x4_16b_bf16 v[72:75], v[68:69], v[24:25], 0 cbsz:3 abid:5
    v_exp_f32 v88, v40
    v_exp_f32 v89, v41
    v_mfma_f32_4x4x4_16b_bf16 v[76:79], v[68:69], v[26:27], 0 cbsz:3 abid:5
    buffer_load_dwordx4 v[24:27], v[118:119], s[12:15], 0 idxen offen
    ds_read_u16 v118, v123 offset:136
    v_exp_f32 v90, v56
    v_exp_f32 v91, v57
    v_pk_add_f32 v[88:89], v[88:89], s[40:41]
    v_pk_fma_f32 v[80:81], v[38:39], v[72:73], v[80:81] op_sel_hi:[0,1,1]
    v_pk_fma_f32 v[82:83], v[38:39], v[74:75], v[82:83] op_sel_hi:[0,1,1]
    v_pk_add_f32 v[90:91], v[90:91], s[40:41]
    v_pk_fma_f32 v[84:85], v[54:55], v[76:77], v[84:85] op_sel_hi:[0,1,1]
    v_pk_fma_f32 v[86:87], v[54:55], v[78:79], v[86:87] op_sel_hi:[0,1,1]
    s_bitcmp1_b32 s44, 22
    s_cbranch_scc1 k2_fl22
k2_bk22:
    s_waitcnt vmcnt(7) lgkmcnt(3)
    v_mfma_f32_4x4x4_16b_bf16 v[72:75], v[70:71], v[28:29], 0 cbsz:3 abid:5
    v_rcp_f32 v88, v88
    v_rcp_f32 v89, v89
    v_mfma_f32_4x4x4_16b_bf16 v[76:79], v[70:71], v[30:31], 0 cbsz:3 abid:5
    buffer_load_dwordx4 v[28:31], v[120:121], s[12:15], 0 idxen offen
    ds_read_u16 v120, v123 offset:140
    v_rcp_f32 v90, v90
    v_rcp_f32 v91, v91
    v_pk_mul_f32 v[40:41], v[40:41], v[88:89]
    v_pk_fma_f32 v[80:81], v[38:39], v[72:73], v[80:81] op_sel:[1,0,0] op_sel_hi:[1,1,1]
    v_pk_fma_f32 v[82:83], v[38:39], v[74:75], v[82:83] op_sel:[1,0,0] op_sel_hi:[1,1,1]
    v_pk_mul_f32 v[56:57], v[56:57], v[90:91]
    v_pk_fma_f32 v[84:85], v[54:55], v[76:77], v[84:85] op_sel:[1,0,0] op_sel_hi:[1,1,1]
    v_pk_fma_f32 v[86:87], v[54:55], v[78:79], v[86:87] op_sel:[1,0,0] op_sel_hi:[1,1,1]
    s_bitcmp1_b32 s44, 23
    s_cbranch_scc1 k2_fl23
k2_bk23:
    s_sub_u32 s43, s43, 1
    s_cmp_eq_u32 s43, s71
    s_cbranch_scc1 k2_th5
k2_tb5:
    s_cmp_gt_u32 s43, 2
    s_cselect_b32 s14, s42, 0
    s_waitcnt vmcnt(7) lgkmcnt(3)
    v_mfma_f32_4x4x4_16b_bf16 v[72:75], v[64:65], v[0:1], 0 cbsz:3 abid:6
    v_exp_f32 v88, v42
    v_exp_f32 v89, v43
    v_mfma_f32_4x4x4_16b_bf16 v[76:79], v[64:65], v[2:3], 0 cbsz:3 abid:6
    buffer_load_dwordx4 v[0:3], v[114:115], s[12:15], 0 idxen offen
    ds_read_u16 v114, v123 offset:144
    v_exp_f32 v90, v58
    v_exp_f32 v91, v59
    v_pk_add_f32 v[88:89], v[88:89], s[40:41]
    v_pk_fma_f32 v[80:81], v[40:41], v[72:73], v[80:81] op_sel_hi:[0,1,1]
    v_pk_fma_f32 v[82:83], v[40:41], v[74:75], v[82:83] op_sel_hi:[0,1,1]
    v_pk_add_f32 v[90:91], v[90:91], s[40:41]
    v_pk_fma_f32 v[84:85], v[56:57], v[76:77], v[84:85] op_sel_hi:[0,1,1]
    v_pk_fma_f32 v[86:87], v[56:57], v[78:79], v[86:87] op_sel_hi:[0,1,1]
    s_bitcmp1_b32 s44, 24
    s_cbranch_scc1 k2_fl24
k2_bk24:
    s_waitcnt vmcnt(7) lgkmcnt(3)
    v_mfma_f32_4x4x4_16b_bf16 v[72:75], v[66:67], v[4:5], 0 cbsz:3 abid:6
    v_rcp_f32 v88, v88
    v_rcp_f32 v89, v89
    v_mfma_f32_4x4x4_16b_bf16 v[76:79], v[66:67], v[6:7], 0 cbsz:3 abid:6
    buffer_load_dwordx4 v[4:7], v[116:117], s[12:15], 0 idxen offen
    ds_read_u16 v116, v123 offset:148
    v_rcp_f32 v90, v90
    v_rcp_f32 v91, v91
    v_pk_mul_f32 v[42:43], v[42:43], v[88:89]
    v_pk_fma_f32 v[80:81], v[40:41], v[72:73], v[80:81] op_sel:[1,0,0] op_sel_hi:[1,1,1]
    v_pk_fma_f32 v[82:83], v[40:41], v[74:75], v[82:83] op_sel:[1,0,0] op_sel_hi:[1,1,1]
    v_pk_mul_f32 v[58:59], v[58:59], v[90:91]
    v_pk_fma_f32 v[84:85], v[56:57], v[76:77], v[84:85] op_sel:[1,0,0] op_sel_hi:[1,1,1]
    v_pk_fma_f32 v[86:87], v[56:57], v[78:79], v[86:87] op_sel:[1,0,0] op_sel_hi:[1,1,1]
    s_bitcmp1_b32 s44, 25
    s_cbranch_scc1 k2_fl25
k2_bk25:
    s_waitcnt vmcnt(7) lgkmcnt(3)
    v_mfma_f32_4x4x4_16b_bf16 v[72:75], v[68:69], v[8:9], 0 cbsz:3 abid:6
    v_exp_f32 v88, v44
    v_exp_f32 v89, v45
    v_mfma_f32_4x4x4_16b_bf16 v[76:79], v[68:69], v[10:11], 0 cbsz:3 abid:6
    buffer_load_dwordx4 v[8:11], v[118:119], s[12:15], 0 idxen offen
    ds_read_u16 v118, v123 offset:152
    v_exp_f32 v90, v60
    v_exp_f32 v91, v61
    v_pk_add_f32 v[88:89], v[88:89], s[40:41]
    v_pk_fma_f32 v[80:81], v[42:43], v[72:73], v[80:81] op_sel_hi:[0,1,1]
    v_pk_fma_f32 v[82:83], v[42:43], v[74:75], v[82:83] op_sel_hi:[0,1,1]
    v_pk_add_f32 v[90:91], v[90:91], s[40:41]
    v_pk_fma_f32 v[84:85], v[58:59], v[76:77], v[84:85] op_sel_hi:[0,1,1]
    v_pk_fma_f32 v[86:87], v[58:59], v[78:79], v[86:87] op_sel_hi:[0,1,1]
    s_bitcmp1_b32 s44, 26
    s_cbranch_scc1 k2_fl26
k2_bk26:
    s_waitcnt vmcnt(7) lgkmcnt(3)
    v_mfma_f32_4x4x4_16b_bf16 v[72:75], v[70:71], v[12:13], 0 cbsz:3 abid:6
    v_rcp_f32 v88, v88
    v_rcp_f32 v89, v89
    v_mfma_f32_4x4x4_16b_bf16 v[76:79], v[70:71], v[14:15], 0 cbsz:3 abid:6
    buffer_load_dwordx4 v[12:15], v[120:121], s[12:15], 0 idxen offen
    ds_read_u16 v120, v123 offset:156
    v_rcp_f32 v90, v90
    v_rcp_f32 v91, v91
    v_pk_mul_f32 v[44:45], v[44:45], v[88:89]
    v_pk_fma_f32 v[80:81], v[42:43], v[72:73], v[80:81] op_sel:[1,0,0] op_sel_hi:[1,1,1]
    v_pk_fma_f32 v[82:83], v[42:43], v[74:75], v[82:83] op_sel:[1,0,0] op_sel_hi:[1,1,1]
    v_pk_mul_f32 v[60:61], v[60:61], v[90:91]
    v_pk_fma_f32 v[84:85], v[58:59], v[76:77], v[84:85] op_sel:[1,0,0] op_sel_hi:[1,1,1]
    v_pk_fma_f32 v[86:87], v[58:59], v[78:79], v[86:87] op_sel:[1,0,0] op_sel_hi:[1,1,1]
    s_bitcmp1_b32 s44, 27
    s_cbranch_scc1 k2_fl27
k2_bk27:
    s_sub_u32 s43, s43, 1
    s_cmp_eq_u32 s43, s71
    s_cbranch_scc1 k2_th6
k2_tb6:
    s_cmp_gt_u32 s43, 2
    s_cselect_b32 s14, s42, 0
    v_and_or_b32 v40, v122, 48, s51
    ds_read_b128 v[32:35], v40
    ds_read_b128 v[36:39], v40 offset:64
    s_waitcnt vmcnt(7) lgkmcnt(3)
    v_mfma_f32_4x4x4_16b_bf16 v[72:75], v[64:65], v[16:17], 0 cbsz:3 abid:7
    v_exp_f32 v88, v46
    v_exp_f32 v89, v47
    v_mfma_f32_4x4x4_16b_bf16 v[76:79], v[64:65], v[18:19], 0 cbsz:3 abid:7
    buffer_load_dwordx4 v[16:19], v[114:115], s[12:15], 0 idxen offen
    ds_read_u16 v114, v123 offset:160
    v_exp_f32 v90, v62
    v_exp_f32 v91, v63
    v_pk_add_f32 v[88:89], v[88:89], s[40:41]
    v_pk_fma_f32 v[80:81], v[44:45], v[72:73], v[80:81] op_sel_hi:[0,1,1]
    v_pk_fma_f32 v[82:83], v[44:45], v[74:75], v[82:83] op_sel_hi:[0,1,1]
    v_pk_add_f32 v[90:91], v[90:91], s[40:41]
    v_pk_fma_f32 v[84:85], v[60:61], v[76:77], v[84:85] op_sel_hi:[0,1,1]
    v_pk_fma_f32 v[86:87], v[60:61], v[78:79], v[86:87] op_sel_hi:[0,1,1]
    s_bitcmp1_b32 s44, 28
    s_cbranch_scc1 k2_fl28
k2_bk28:
    s_waitcnt vmcnt(7) lgkmcnt(3)
    v_mfma_f32_4x4x4_16b_bf16 v[72:75], v[66:67], v[20:21], 0 cbsz:3 abid:7
    v_rcp_f32 v88, v88
    v_rcp_f32 v89, v89
    v_mfma_f32_4x4x4_16b_bf16 v[76:79], v[66:67], v[22:23], 0 cbsz:3 abid:7
    buffer_load_dwordx4 v[20:23], v[116:117], s[12:15], 0 idxen offen
    ds_read_u16 v116, v123 offset:164
    v_rcp_f32 v90, v90
    v_rcp_f32 v91, v91
    v_pk_mul_f32 v[46:47], v[46:47], v[88:89]
    v_pk_fma_f32 v[80:81], v[44:45], v[72:73], v[80:81] op_sel:[1,0,0] op_sel_hi:[1,1,1]
    v_pk_fma_f32 v[82:83], v[44:45], v[74:75], v[82:83] op_sel:[1,0,0] op_sel_hi:[1,1,1]
    v_pk_mul_f32 v[62:63], v[62:63], v[90:91]
    v_pk_fma_f32 v[84:85], v[60:61], v[76:77], v[84:85] op_sel:[1,0,0] op_sel_hi:[1,1,1]
    v_pk_fma_f32 v[86:87], v[60:61], v[78:79], v[86:87] op_sel:[1,0,0] op_sel_hi:[1,1,1]
    s_bitcmp1_b32 s44, 29
    s_cbranch_scc1 k2_fl29
k2_bk29:
    s_waitcnt vmcnt(7) lgkmcnt(3)
    v_mfma_f32_4x4x4_16b_bf16 v[72:75], v[68:69], v[24:25], 0 cbsz:3 abid:7
    v_mfma_f32_4x4x4_16b_bf16 v[76:79], v[68:69], v[26:27], 0 cbsz:3 abid:7
    buffer_load_dwordx4 v[24:27], v[118:119], s[12:15], 0 idxen offen
    ds_read_u16 v118, v123 offset:168
    s_nop 2
    v_pk_fma_f32 v[80:81], v[46:47], v[72:73], v[80:81] op_sel_hi:[0,1,1]
    v_pk_fma_f32 v[82:83], v[46:47], v[74:75], v[82:83] op_sel_hi:[0,1,1]
    v_pk_fma_f32 v[84:85], v[62:63], v[76:77], v[84:85] op_sel_hi:[0,1,1]
    v_pk_fma_f32 v[86:87], v[62:63], v[78:79], v[86:87] op_sel_hi:[0,1,1]
    s_bitcmp1_b32 s44, 30
    s_cbranch_scc1 k2_fl30
k2_bk30:
    s_waitcnt vmcnt(7) lgkmcnt(3)
    v_mfma_f32_4x4x4_16b_bf16 v[72:75], v[70:71], v[28:29], 0 cbsz:3 abid:7
    v_mfma_f32_4x4x4_16b_bf16 v[76:79], v[70:71], v[30:31], 0 cbsz:3 abid:7
    buffer_load_dwordx4 v[28:31], v[120:121], s[12:15], 0 idxen offen
    ds_read_u16 v120, v123 offset:172
    s_nop 2
    v_pk_fma_f32 v[80:81], v[46:47], v[72:73], v[80:81] op_sel:[1,0,0] op_sel_hi:[1,1,1]
    v_pk_fma_f32 v[82:83], v[46:47], v[74:75], v[82:83] op_sel:[1,0,0] op_sel_hi:[1,1,1]
    v_pk_fma_f32 v[84:85], v[62:63], v[76:77], v[84:85] op_sel:[1,0,0] op_sel_hi:[1,1,1]
    v_pk_fma_f32 v[86:87], v[62:63], v[78:79], v[86:87] op_sel:[1,0,0] op_sel_hi:[1,1,1]
    s_bitcmp1_b32 s44, 31
    s_cbranch_scc1 k2_fl31
k2_bk31:
    s_sub_u32 s43, s43, 1
    s_cmp_eq_u32 s43, s71
    s_cbranch_scc1 k2_th7
k2_tb7:
    s_mov_b32 s44, s45
    s_mov_b32 s45, s46
    v_add_u32 v123, 128, v123
    s_branch k2_blk
k2_th0:
    s_cmp_eq_u32 s71, 0
    s_cbranch_scc1 k2_done
    s_call_b64 s[60:61], k2_thr
    s_branch k2_tb0
k2_th1:
    s_cmp_eq_u32 s71, 0
    s_cbranch_scc1 k2_done
    s_call_b64 s[60:61], k2_thr
    s_branch k2_tb1
k2_th2:
    s_cmp_eq_u32 s71, 0
    s_cbranch_scc1 k2_done
    s_call_b64 s[60:61], k2_thr
    s_branch k2_tb2
k2_th3:
    s_cmp_eq_u32 s71, 0
    s_cbranch_scc1 k2_done
    s_call_b64 s[60:61], k2_thr
    s_branch k2_tb3
k2_th4:
    s_cmp_eq_u32 s71, 0
    s_cbranch_scc1 k2_done
    s_call_b64 s[60:61], k2_thr
    s_branch k2_tb4
k2_th5:
    s_cmp_eq_u32 s71, 0
    s_cbranch_scc1 k2_done
    s_call_b64 s[60:61], k2_thr
    s_branch k2_tb5
k2_th6:
    s_cmp_eq_u32 s71, 0
    s_cbranch_scc1 k2_done
    s_call_b64 s[60:61], k2_thr
    s_branch k2_tb6
k2_th7:
    s_cmp_eq_u32 s71, 0
    s_cbranch_scc1 k2_done
    s_call_b64 s[60:61], k2_thr
    s_branch k2_tb7
k2_thr:
    s_lshr_b32 s71, s71, 1
    s_sub_u32 s11, s11, 1
    s_cmp_eq_u32 s11, 2
    s_cbranch_scc1 k2_p2
    s_cmp_eq_u32 s11, 1
    s_cbranch_scc1 k2_p1x
    s_mov_b32 s71, 0
    s_setprio 0
    s_setpc_b64 s[60:61]
k2_p2:
    s_setprio 2
    s_setpc_b64 s[60:61]
k2_p1x:
    s_setprio 1
    s_setpc_b64 s[60:61]
k2_fl0:
    s_call_b64 s[60:61], k2_flush
    s_branch k2_bk0
k2_fl1:
    s_call_b64 s[60:61], k2_flush
    s_branch k2_bk1
k2_fl2:
    s_call_b64 s[60:61], k2_flush
    s_branch k2_bk2
k2_fl3:
    s_call_b64 s[60:61], k2_flush
    s_branch k2_bk3
k2_fl4:
    s_call_b64 s[60:61], k2_flush
    s_branch k2_bk4
k2_fl5:
    s_call_b64 s[60:61], k2_flush
    s_branch k2_bk5
k2_fl6:
    s_call_b64 s[60:61], k2_flush
    s_branch k2_bk6
k2_fl7:
    s_call_b64 s[60:61], k2_flush
    s_branch k2_bk7
k2_fl8:
    s_call_b64 s[60:61], k2_flush
    s_branch k2_bk8
k2_fl9:
    s_call_b64 s[60:61], k2_flush
    s_branch k2_bk9
k2_fl10:
    s_call_b64 s[60:61], k2_flush
    s_branch k2_bk10
k2_fl11:
    s_call_b64 s[60:61], k2_flush
    s_branch k2_bk11
k2_fl12:
    s_call_b64 s[60:61], k2_flush
    s_branch k2_bk12
k2_fl13:
    s_call_b64 s[60:61], k2_flush
    s_branch k2_bk13
k2_fl14:
    s_call_b64 s[60:61], k2_flush
    s_branch k2_bk14
k2_fl15:
    s_call_b64 s[60:61], k2_flush
    s_branch k2_bk15
k2_fl16:
    s_call_b64 s[60:61], k2_flush
    s_branch k2_bk16
k2_fl17:
    s_call_b64 s[60:61], k2_flush
    s_branch k2_bk17
k2_fl18:
    s_call_b64 s[60:61], k2_flush
    s_branch k2_bk18
k2_fl19:
    s_call_b64 s[60:61], k2_flush
    s_branch k2_bk19
k2_fl20:
    s_call_b64 s[60:61], k2_flush
    s_branch k2_bk20
k2_fl21:
    s_call_b64 s[60:61], k2_flush
    s_branch k2_bk21
k2_fl22:
    s_call_b64 s[60:61], k2_flush
    s_branch k2_bk22
k2_fl23:
    s_call_b64 s[60:61], k2_flush
    s_branch k2_bk23
k2_fl24:
    s_call_b64 s[60:61], k2_flush
    s_branch k2_bk24
k2_fl25:
    s_call_b64 s[60:61], k2_flush
    s_branch k2_bk25
k2_fl26:
    s_call_b64 s[60:61], k2_flush
    s_branch k2_bk26
k2_fl27:
    s_call_b64 s[60:61], k2_flush
    s_branch k2_bk27
k2_fl28:
    s_call_b64 s[60:61], k2_flush
    s_branch k2_bk28
k2_fl29:
    s_call_b64 s[60:61], k2_flush
    s_branch k2_bk29
k2_fl30:
    s_call_b64 s[60:61], k2_flush
    s_branch k2_bk30
k2_fl31:
    s_call_b64 s[60:61], k2_flush
    s_branch k2_bk31
k2_open:
    s_cmp_eq_u32 s70, 0
    s_cbranch_scc1 k2_openret
    s_cmp_eq_u64 s[88:89], 0
    s_cbranch_scc0 k2_flb
k2_openret:
    s_setpc_b64 s[60:61]
k2_flush:
    s_cmp_eq_u32 s90, 0
    s_cbranch_scc1 k2_flb
    s_sub_u32 s90, s90, 1
    s_ff1_i32_b64 s50, s[48:49]
    s_bitset0_b64 s[48:49], s50
    s_branch k2_flb3
k2_flb:
    s_ff1_i32_b64 s50, s[88:89]
    s_bitset0_b64 s[88:89], s50
k2_flb3:
    s_lshl_b32 s58, s50, 10
    s_and_b32 s59, s50, 7
    s_lshl_b32 s59, s59, 4
    s_or_b32 s58, s58, s59
    s_lshl_b32 s59, s50, 2
    v_xor_b32 v72, s58, v126
    v_mov_b32 v73, s59
    s_mov_b64 exec, 1
    ds_wrxchg_rtn_b32 v74, v73, v123 offset:52480
    s_mov_b64 exec, -1
    ds_read_b128 v[76:79], v72 offset:0
    v_permlane32_swap_b32 v80, v84
    v_permlane32_swap_b32 v81, v85
    v_permlane32_swap_b32 v82, v86
    v_permlane32_swap_b32 v83, v87
    v_pk_add_f32 v[80:81], v[80:81], v[84:85]
    v_pk_add_f32 v[82:83], v[82:83], v[86:87]
    v_mov_b64 v[84:85], 0
    v_mov_b64 v[86:87], 0
k2_flw:
    s_waitcnt lgkmcnt(0)
    v_readfirstlane_b32 s3, v74
    s_cmp_lg_u32 s3, 0
    s_cbranch_scc1 k2_flr
    v_pk_add_f32 v[76:77], v[76:77], v[80:81]
    v_pk_add_f32 v[78:79], v[78:79], v[82:83]
    v_mov_b64 v[80:81], 0
    v_mov_b64 v[82:83], 0
    ds_write_b128 v72, v[76:79] offset:0
    s_mov_b64 exec, 1
    ds_write_b32 v73, v80 offset:52480
    s_mov_b64 exec, -1
    s_setpc_b64 s[60:61]
k2_flr:
    s_mov_b64 exec, 1
    ds_wrxchg_rtn_b32 v74, v73, v123 offset:52480
    s_mov_b64 exec, -1
    ds_read_b128 v[76:79], v72 offset:0
    s_branch k2_flw
k2_done:
    s_waitcnt vmcnt(0)
    s_add_u32 s35, s35, 2720
    v_and_b32 v122, 63, v127
    s_cmp_lt_u32 s35, s36
    s_cbranch_scc0 k2_last
    s_waitcnt lgkmcnt(0)
    s_barrier
    v_lshlrev_b32 v1, 4, v127
    v_mov_b64 v[8:9], 0
    v_mov_b64 v[10:11], 0
    ds_write_b128 v1, v[8:11] offset:40960
    s_mov_b32 s61, 0
    s_waitcnt lgkmcnt(0)
    s_barrier
    s_cmp_lg_u32 s32, 15
    s_cbranch_scc1 k2_p1
    s_branch k2_tg
k2_last:
    s_cmp_ge_u32 s32, 5
    s_cbranch_scc1 k2_nowm
    v_lshlrev_b32 v64, 4, v122
    s_mov_b32 s58, 262144
    s_mov_b32 s59, 266240
    buffer_load_dwordx4 v[0:3], v64, s[24:27], s58 offen offset:0 sc1
    buffer_load_dwordx4 v[4:7], v64, s[24:27], s58 offen offset:1024 sc1
    buffer_load_dwordx4 v[8:11], v64, s[24:27], s58 offen offset:2048 sc1
    buffer_load_dwordx4 v[12:15], v64, s[24:27], s58 offen offset:3072 sc1
    buffer_load_dwordx4 v[16:19], v64, s[24:27], s59 offen offset:0 sc1
    buffer_load_dwordx4 v[20:23], v64, s[24:27], s59 offen offset:1024 sc1
    buffer_load_dwordx4 v[24:27], v64, s[24:27], s59 offen offset:2048 sc1
    buffer_load_dwordx4 v[28:31], v64, s[24:27], s59 offen offset:3072 sc1
k2_nowm:
    v_and_b32 v64, 31, v122
    v_lshrrev_b32 v65, 5, v122
    v_lshrrev_b32 v66, 2, v64
    v_mul_u32_u24 v66, 1040, v66
    v_lshl_add_u32 v66, v65, 7, v66
    v_and_b32 v67, 3, v64
    v_lshl_add_u32 v66, v67, 2, v66
    s_lshl_b32 s3, s32, 13
    v_add_u32 v113, s3, v66
    v_lshlrev_b32 v64, 4, v64
    v_lshl_add_u32 v112, v65, 9, v64
    v_xor_b32 v114, 16, v113
    v_xor_b32 v115, 32, v113
    v_xor_b32 v116, 48, v113
    v_xor_b32 v117, 64, v113
    v_xor_b32 v118, 80, v113
    v_xor_b32 v119, 96, v113
    v_xor_b32 v120, 112, v113
    s_lshl_b32 s3, s32, 12
    s_mov_b32 s10, 0xbf317218
    s_mov_b32 s11, 0xbf317218
    s_waitcnt lgkmcnt(0)
    s_barrier
    s_cmp_ge_u32 s32, 5
    s_cbranch_scc1 k2_end
    ds_read2st64_b32 v[32:33], v113 offset0:0 offset1:1
    ds_read2st64_b32 v[34:35], v113 offset0:2 offset1:3
    ds_read2st64_b32 v[36:37], v114 offset0:0 offset1:1
    ds_read2st64_b32 v[38:39], v114 offset0:2 offset1:3
    ds_read2st64_b32 v[40:41], v115 offset0:0 offset1:1
    ds_read2st64_b32 v[42:43], v115 offset0:2 offset1:3
    ds_read2st64_b32 v[44:45], v116 offset0:0 offset1:1
    ds_read2st64_b32 v[46:47], v116 offset0:2 offset1:3
    ds_read2st64_b32 v[48:49], v117 offset0:0 offset1:1
    ds_read2st64_b32 v[50:51], v117 offset0:2 offset1:3
    ds_read2st64_b32 v[52:53], v118 offset0:0 offset1:1
    ds_read2st64_b32 v[54:55], v118 offset0:2 offset1:3
    ds_read2st64_b32 v[56:57], v119 offset0:0 offset1:1
    ds_read2st64_b32 v[58:59], v119 offset0:2 offset1:3
    ds_read2st64_b32 v[60:61], v120 offset0:0 offset1:1
    ds_read2st64_b32 v[62:63], v120 offset0:2 offset1:3
    s_waitcnt lgkmcnt(12)
    v_pk_mul_f32 v[32:33], v[32:33], s[10:11]
    v_pk_mul_f32 v[34:35], v[34:35], s[10:11]
    v_pk_mul_f32 v[36:37], v[36:37], s[10:11]
    v_pk_mul_f32 v[38:39], v[38:39], s[10:11]
    v_cvt_pk_bf16_f32 v64, v32, v36
    v_cvt_pk_bf16_f32 v68, v33, v37
    v_cvt_pk_bf16_f32 v72, v34, v38
    v_cvt_pk_bf16_f32 v76, v35, v39
    s_waitcnt lgkmcnt(8)
    v_pk_mul_f32 v[40:41], v[40:41], s[10:11]
    v_pk_mul_f32 v[42:43], v[42:43], s[10:11]
    v_pk_mul_f32 v[44:45], v[44:45], s[10:11]
    v_pk_mul_f32 v[46:47], v[46:47], s[10:11]
    v_cvt_pk_bf16_f32 v65, v40, v44
    v_cvt_pk_bf16_f32 v69, v41, v45
    v_cvt_pk_bf16_f32 v73, v42, v46
    v_cvt_pk_bf16_f32 v77, v43, v47
    s_waitcnt lgkmcnt(4)
    v_pk_mul_f32 v[48:49], v[48:49], s[10:11]
    v_pk_mul_f32 v[50:51], v[50:51], s[10:11]
    v_pk_mul_f32 v[52:53], v[52:53], s[10:11]
    v_pk_mul_f32 v[54:55], v[54:55], s[10:11]
    v_cvt_pk_bf16_f32 v66, v48, v52
    v_cvt_pk_bf16_f32 v70, v49, v53
    v_cvt_pk_bf16_f32 v74, v50, v54
    v_cvt_pk_bf16_f32 v78, v51, v55
    s_waitcnt lgkmcnt(0)
    v_pk_mul_f32 v[56:57], v[56:57], s[10:11]
    v_pk_mul_f32 v[58:59], v[58:59], s[10:11]
    v_pk_mul_f32 v[60:61], v[60:61], s[10:11]
    v_pk_mul_f32 v[62:63], v[62:63], s[10:11]
    v_cvt_pk_bf16_f32 v67, v56, v60
    v_cvt_pk_bf16_f32 v71, v57, v61
    v_cvt_pk_bf16_f32 v75, v58, v62
    v_cvt_pk_bf16_f32 v79, v59, v63
    s_waitcnt vmcnt(0)
    s_nop 0
    v_mfma_f32_32x32x16_bf16 v[80:95], v[64:67], v[0:3], 0
    v_mfma_f32_32x32x16_bf16 v[96:111], v[64:67], v[4:7], 0
    v_mfma_f32_32x32x16_bf16 v[80:95], v[68:71], v[8:11], v[80:95]
    v_mfma_f32_32x32x16_bf16 v[96:111], v[68:71], v[12:15], v[96:111]
    v_mfma_f32_32x32x16_bf16 v[80:95], v[72:75], v[16:19], v[80:95]
    v_mfma_f32_32x32x16_bf16 v[96:111], v[72:75], v[20:23], v[96:111]
    v_mfma_f32_32x32x16_bf16 v[80:95], v[76:79], v[24:27], v[80:95]
    v_mfma_f32_32x32x16_bf16 v[96:111], v[76:79], v[28:31], v[96:111]
    s_nop 10
    v_cvt_pk_bf16_f32 v32, v80, v81
    v_cvt_pk_bf16_f32 v33, v82, v83
    v_cvt_pk_bf16_f32 v34, v96, v97
    v_cvt_pk_bf16_f32 v35, v98, v99
    buffer_store_dwordx4 v[32:35], v112, s[28:31], s3 offen offset:0 sc1
    v_cvt_pk_bf16_f32 v36, v84, v85
    v_cvt_pk_bf16_f32 v37, v86, v87
    v_cvt_pk_bf16_f32 v38, v100, v101
    v_cvt_pk_bf16_f32 v39, v102, v103
    buffer_store_dwordx4 v[36:39], v112, s[28:31], s3 offen offset:1024 sc1
    v_cvt_pk_bf16_f32 v40, v88, v89
    v_cvt_pk_bf16_f32 v41, v90, v91
    v_cvt_pk_bf16_f32 v42, v104, v105
    v_cvt_pk_bf16_f32 v43, v106, v107
    buffer_store_dwordx4 v[40:43], v112, s[28:31], s3 offen offset:2048 sc1
    v_cvt_pk_bf16_f32 v44, v92, v93
    v_cvt_pk_bf16_f32 v45, v94, v95
    v_cvt_pk_bf16_f32 v46, v108, v109
    v_cvt_pk_bf16_f32 v47, v110, v111
    buffer_store_dwordx4 v[44:47], v112, s[28:31], s3 offen offset:3072 sc1
k2_end:
    s_endpgm

.section .rodata,"a"
.p2align 6
.amdhsa_kernel gather_scatter__tensor_product_equiv_tfn__graph_kernel
  .amdhsa_next_free_vgpr 128
  .amdhsa_next_free_sgpr 102
  .amdhsa_accum_offset 128
  .amdhsa_group_segment_fixed_size 0
  .amdhsa_kernarg_size 88
  .amdhsa_user_sgpr_count 2
  .amdhsa_user_sgpr_kernarg_segment_ptr 1
  .amdhsa_system_sgpr_workgroup_id_x 1
.end_amdhsa_kernel
```
